```python
import torch

def _softmax(x, axis=-1):
    return torch.softmax(x, dim=axis)
def _gelu(x):
    return torch.nn.functional.gelu(x, approximate="tanh")
def _silu(x):
    return torch.nn.functional.silu(x)
def _sigmoid(x):
    return torch.sigmoid(x)
def _layernorm(x, axis=-1, eps=1e-5):
    m = x.mean(dim=axis, keepdim=True)
    v = x.var(dim=axis, keepdim=True, unbiased=False)
    return (x - m) / torch.sqrt(v + eps)
def _scatter_add(tgt, idx, src, axis=0):
    return tgt.clone().index_add_(axis, idx, src)
def _segment_sum(src, seg, n):
    out = torch.zeros((n,) + src.shape[1:], dtype=src.dtype)
    return out.index_add_(0, seg, src)
def _pad(x, pw):
    flat = tuple(v for pair in reversed(pw) for v in pair)
    return torch.nn.functional.pad(x, flat)

kernel_name = 'parallel_sum__mha_block__swiglu_ffn__prompt'

def setup_inputs():

    _w = (lambda a: (lambda t: t.to(torch.bfloat16) if t.is_floating_point() else t)(torch.as_tensor(a)))
    def _A_setup():
        B, S, D, H = 1, 2048, 1024, 32
        return {
            "x": _w((lambda *s: torch.randn(*s, dtype=torch.bfloat16) * 0.05)(B, S, D)),
            "wqkv": _w((lambda *s: torch.randn(*s, dtype=torch.bfloat16) * 0.05)(D, 3 * D)),
            "wo": _w((lambda *s: torch.randn(*s, dtype=torch.bfloat16) * 0.05)(D, D)),
        }
    _A_in = _A_setup()

    def _B_setup():
        B, S, D, F = 1, 2048, 1024, 3584
        return {
            "x": _w((lambda *s: torch.randn(*s, dtype=torch.bfloat16) * 0.05)(B, S, D)),
            "w_gate": _w((lambda *s: torch.randn(*s, dtype=torch.bfloat16) * 0.05)(D, F)),
            "w_up": _w((lambda *s: torch.randn(*s, dtype=torch.bfloat16) * 0.05)(D, F)),
            "w_down": _w((lambda *s: torch.randn(*s, dtype=torch.bfloat16) * 0.05)(F, D)),
        }
    _B_in = _B_setup()

    return {
        "A_x": _A_in["x"],
        "A_wqkv": _A_in["wqkv"],
        "A_wo": _A_in["wo"],
        "B_x": _B_in["x"],
        "B_w_gate": _B_in["w_gate"],
        "B_w_up": _B_in["w_up"],
        "B_w_down": _B_in["w_down"],
    }

def reference(A_x, A_wqkv, A_wo, B_x, B_w_gate, B_w_up, B_w_down):
    def _A_ref(x, wqkv, wo):
        B, S, D = x.shape
        H = 32
        Dh = D // H
        qkv = (lambda x, *d: x.permute(*d))((x @ wqkv).reshape(B, S, 3, H, Dh), 2, 0, 3, 1, 4)
        q, k, v = qkv[0], qkv[1], qkv[2]
        scores = torch.einsum("bhqd,bhkd->bhqk", q, k) * (Dh ** -0.5)
        p = _softmax(scores, axis=-1)
        o = torch.einsum("bhqk,bhkd->bhqd", p, v)
        return (lambda x, *d: x.permute(*d))(o, 0, 2, 1, 3).reshape(B, S, D) @ wo

    def _B_ref(x, w_gate, w_up, w_down):
        g = _silu(x @ w_gate)
        u = x @ w_up
        return (g * u) @ w_down

    x = A_x
    xn = _layernorm(x, axis=-1)
    return x + _A_ref(xn, A_wqkv, A_wo) + _B_ref(xn, B_w_gate, B_w_up, B_w_down)
```

```asm
; @launch kernel=ln_kernel grid=(512,1,1) block=(256,1,1) lds=0
; @launch kernel=gemm1_kernel grid=(256,1,1) block=(512,1,1) lds=147456
; @launch kernel=mid_kernel grid=(768,1,1) block=(256,1,1) lds=49152
.amdgcn_target "amdgcn-amd-amdhsa--gfx950"
.text
.globl ln_kernel
.p2align 8
.type ln_kernel,@function
ln_kernel:
    s_cmp_ge_u32 s2, 512
    s_cbranch_scc1 L_ln_done
    s_load_dwordx2 s[4:5], s[0:1], 0
    s_load_dwordx2 s[6:7], s[0:1], 72
    s_load_dwordx2 s[22:23], s[0:1], 8
    s_load_dwordx2 s[24:25], s[0:1], 32
    s_load_dwordx2 s[26:27], s[0:1], 40
    v_lshrrev_b32 v1, 6, v0
    v_and_b32 v2, 63, v0
    s_lshl_b32 s3, s2, 2
    v_add_u32 v1, s3, v1
    v_lshlrev_b32 v1, 11, v1
    v_lshl_add_u32 v1, v2, 4, v1
    s_waitcnt lgkmcnt(0)
    s_mov_b32 s8, s4
    s_and_b32 s9, s5, 0xffff
    s_mov_b32 s10, 0x400000
    s_mov_b32 s11, 0x20000
    s_add_u32 s12, s6, 0
    s_addc_u32 s13, s7, 0
    s_and_b32 s13, s13, 0xffff
    s_mov_b32 s14, 0x400000
    s_mov_b32 s15, 0x20000
    buffer_load_dwordx4 v[4:7], v1, s[8:11], 0 offen
    buffer_load_dwordx4 v[8:11], v1, s[8:11], 0 offen offset:1024
    s_waitcnt vmcnt(0)
    v_lshlrev_b32 v16, 16, v4
    v_and_b32 v17, 0xffff0000, v4
    v_lshlrev_b32 v18, 16, v5
    v_and_b32 v19, 0xffff0000, v5
    v_lshlrev_b32 v20, 16, v6
    v_and_b32 v21, 0xffff0000, v6
    v_lshlrev_b32 v22, 16, v7
    v_and_b32 v23, 0xffff0000, v7
    v_lshlrev_b32 v24, 16, v8
    v_and_b32 v25, 0xffff0000, v8
    v_lshlrev_b32 v26, 16, v9
    v_and_b32 v27, 0xffff0000, v9
    v_lshlrev_b32 v28, 16, v10
    v_and_b32 v29, 0xffff0000, v10
    v_lshlrev_b32 v30, 16, v11
    v_and_b32 v31, 0xffff0000, v11
    v_add_f32 v32, v16, v17
    v_add_f32 v32, v32, v18
    v_add_f32 v32, v32, v19
    v_add_f32 v32, v32, v20
    v_add_f32 v32, v32, v21
    v_add_f32 v32, v32, v22
    v_add_f32 v32, v32, v23
    v_add_f32 v32, v32, v24
    v_add_f32 v32, v32, v25
    v_add_f32 v32, v32, v26
    v_add_f32 v32, v32, v27
    v_add_f32 v32, v32, v28
    v_add_f32 v32, v32, v29
    v_add_f32 v32, v32, v30
    v_add_f32 v32, v32, v31
    s_nop 1
    v_add_f32_dpp v32, v32, v32 quad_perm:[1,0,3,2] row_mask:0xf bank_mask:0xf
    s_nop 1
    v_add_f32_dpp v32, v32, v32 quad_perm:[2,3,0,1] row_mask:0xf bank_mask:0xf
    s_nop 1
    v_add_f32_dpp v32, v32, v32 row_half_mirror row_mask:0xf bank_mask:0xf
    s_nop 1
    v_add_f32_dpp v32, v32, v32 row_mirror row_mask:0xf bank_mask:0xf
    s_nop 1
    v_readlane_b32 s16, v32, 0
    v_readlane_b32 s17, v32, 16
    v_readlane_b32 s18, v32, 32
    v_readlane_b32 s19, v32, 48
    s_nop 1
    v_mov_b32 v32, s16
    v_add_f32 v32, s17, v32
    v_add_f32 v32, s18, v32
    v_add_f32 v32, s19, v32
    v_mul_f32 v32, 0x3a800000, v32
    v_sub_f32 v34, v16, v32
    v_mul_f32 v33, v34, v34
    v_sub_f32 v34, v17, v32
    v_fmac_f32 v33, v34, v34
    v_sub_f32 v34, v18, v32
    v_fmac_f32 v33, v34, v34
    v_sub_f32 v34, v19, v32
    v_fmac_f32 v33, v34, v34
    v_sub_f32 v34, v20, v32
    v_fmac_f32 v33, v34, v34
    v_sub_f32 v34, v21, v32
    v_fmac_f32 v33, v34, v34
    v_sub_f32 v34, v22, v32
    v_fmac_f32 v33, v34, v34
    v_sub_f32 v34, v23, v32
    v_fmac_f32 v33, v34, v34
    v_sub_f32 v34, v24, v32
    v_fmac_f32 v33, v34, v34
    v_sub_f32 v34, v25, v32
    v_fmac_f32 v33, v34, v34
    v_sub_f32 v34, v26, v32
    v_fmac_f32 v33, v34, v34
    v_sub_f32 v34, v27, v32
    v_fmac_f32 v33, v34, v34
    v_sub_f32 v34, v28, v32
    v_fmac_f32 v33, v34, v34
    v_sub_f32 v34, v29, v32
    v_fmac_f32 v33, v34, v34
    v_sub_f32 v34, v30, v32
    v_fmac_f32 v33, v34, v34
    v_sub_f32 v34, v31, v32
    v_fmac_f32 v33, v34, v34
    s_nop 1
    v_add_f32_dpp v33, v33, v33 quad_perm:[1,0,3,2] row_mask:0xf bank_mask:0xf
    s_nop 1
    v_add_f32_dpp v33, v33, v33 quad_perm:[2,3,0,1] row_mask:0xf bank_mask:0xf
    s_nop 1
    v_add_f32_dpp v33, v33, v33 row_half_mirror row_mask:0xf bank_mask:0xf
    s_nop 1
    v_add_f32_dpp v33, v33, v33 row_mirror row_mask:0xf bank_mask:0xf
    s_nop 1
    v_readlane_b32 s16, v33, 0
    v_readlane_b32 s17, v33, 16
    v_readlane_b32 s18, v33, 32
    v_readlane_b32 s19, v33, 48
    s_nop 1
    v_mov_b32 v33, s16
    v_add_f32 v33, s17, v33
    v_add_f32 v33, s18, v33
    v_add_f32 v33, s19, v33
    v_mul_f32 v33, 0x3a800000, v33
    v_cvt_pk_bf16_f32 v32, v32, v32
    v_lshlrev_b32 v32, 16, v32
    v_cvt_pk_bf16_f32 v33, v33, v33
    v_lshlrev_b32 v33, 16, v33
    v_add_f32 v33, 0x3727c5ac, v33
    v_cvt_pk_bf16_f32 v33, v33, v33
    v_lshlrev_b32 v33, 16, v33
    v_sqrt_f32 v33, v33
    s_nop 0
    v_cvt_pk_bf16_f32 v33, v33, v33
    v_lshlrev_b32 v33, 16, v33
    v_rcp_f32 v35, v33
    s_nop 0
    v_fma_f32 v36, -v33, v35, 1.0
    v_fma_f32 v35, v36, v35, v35
    v_sub_f32 v16, v16, v32
    v_sub_f32 v17, v17, v32
    v_sub_f32 v18, v18, v32
    v_sub_f32 v19, v19, v32
    v_sub_f32 v20, v20, v32
    v_sub_f32 v21, v21, v32
    v_sub_f32 v22, v22, v32
    v_sub_f32 v23, v23, v32
    v_sub_f32 v24, v24, v32
    v_sub_f32 v25, v25, v32
    v_sub_f32 v26, v26, v32
    v_sub_f32 v27, v27, v32
    v_sub_f32 v28, v28, v32
    v_sub_f32 v29, v29, v32
    v_sub_f32 v30, v30, v32
    v_sub_f32 v31, v31, v32
    v_cvt_pk_bf16_f32 v4, v16, v17
    v_cvt_pk_bf16_f32 v5, v18, v19
    v_cvt_pk_bf16_f32 v6, v20, v21
    v_cvt_pk_bf16_f32 v7, v22, v23
    v_cvt_pk_bf16_f32 v8, v24, v25
    v_cvt_pk_bf16_f32 v9, v26, v27
    v_cvt_pk_bf16_f32 v10, v28, v29
    v_cvt_pk_bf16_f32 v11, v30, v31
    v_lshlrev_b32 v16, 16, v4
    v_and_b32 v17, 0xffff0000, v4
    v_lshlrev_b32 v18, 16, v5
    v_and_b32 v19, 0xffff0000, v5
    v_lshlrev_b32 v20, 16, v6
    v_and_b32 v21, 0xffff0000, v6
    v_lshlrev_b32 v22, 16, v7
    v_and_b32 v23, 0xffff0000, v7
    v_lshlrev_b32 v24, 16, v8
    v_and_b32 v25, 0xffff0000, v8
    v_lshlrev_b32 v26, 16, v9
    v_and_b32 v27, 0xffff0000, v9
    v_lshlrev_b32 v28, 16, v10
    v_and_b32 v29, 0xffff0000, v10
    v_lshlrev_b32 v30, 16, v11
    v_and_b32 v31, 0xffff0000, v11
    v_mul_f32 v16, v16, v35
    v_mul_f32 v17, v17, v35
    v_mul_f32 v18, v18, v35
    v_mul_f32 v19, v19, v35
    v_mul_f32 v20, v20, v35
    v_mul_f32 v21, v21, v35
    v_mul_f32 v22, v22, v35
    v_mul_f32 v23, v23, v35
    v_mul_f32 v24, v24, v35
    v_mul_f32 v25, v25, v35
    v_mul_f32 v26, v26, v35
    v_mul_f32 v27, v27, v35
    v_mul_f32 v28, v28, v35
    v_mul_f32 v29, v29, v35
    v_mul_f32 v30, v30, v35
    v_mul_f32 v31, v31, v35
    v_cvt_pk_bf16_f32 v4, v16, v17
    v_cvt_pk_bf16_f32 v5, v18, v19
    v_cvt_pk_bf16_f32 v6, v20, v21
    v_cvt_pk_bf16_f32 v7, v22, v23
    v_cvt_pk_bf16_f32 v8, v24, v25
    v_cvt_pk_bf16_f32 v9, v26, v27
    v_cvt_pk_bf16_f32 v10, v28, v29
    v_cvt_pk_bf16_f32 v11, v30, v31
    buffer_store_dwordx4 v[4:7], v1, s[12:15], 0 offen
    buffer_store_dwordx4 v[8:11], v1, s[12:15], 0 offen offset:1024
    s_cmp_lg_u32 s2, 0
    s_cbranch_scc1 L_ln_done
    v_lshlrev_b32 v1, 3, v0
    v_add_u32 v1, 62914560, v1
    v_mov_b32 v2, 0
    v_mov_b32 v3, 0
    global_store_dwordx2 v1, v[2:3], s[6:7]
L_ln_done:
    s_endpgm
.globl gemm1_kernel
.p2align 8
.type gemm1_kernel,@function
gemm1_kernel:
    s_cmp_ge_u32 s2, 256
    s_cbranch_scc1 L_g1_done
    s_load_dwordx2 s[70:71], s[0:1], 8
    s_load_dwordx2 s[72:73], s[0:1], 32
    s_load_dwordx2 s[74:75], s[0:1], 40
    s_load_dwordx2 s[76:77], s[0:1], 72
    s_load_dwordx2 s[36:37], s[0:1], 0
    s_load_dwordx2 s[40:41], s[0:1], 64
    s_load_dwordx2 s[44:45], s[0:1], 48
    s_load_dwordx2 s[46:47], s[0:1], 16
    v_lshrrev_b32 v1, 6, v0
    v_and_b32 v2, 63, v0
    s_nop 0
    v_readfirstlane_b32 s54, v1
    s_and_b32 s78, s2, 7
    s_lshr_b32 s79, s2, 3
    s_and_b32 s80, s79, 7
    s_lshr_b32 s79, s79, 3
    s_lshl_b32 s78, s78, 2
    s_add_u32 s79, s79, s78
    s_cmp_eq_u32 s79, 9
    s_cselect_b32 s81, 2, 5
    s_cselect_b32 s82, 6, 0
    s_mul_i32 s83, s79, 160
    s_sub_u32 s83, s83, 1536
    s_cmp_eq_u32 s79, 9
    s_cselect_b32 s83, 0, s83
    s_waitcnt lgkmcnt(0)
    s_mov_b32 s4, s76
    s_and_b32 s5, s77, 0xffff
    s_mov_b32 s6, 268435456
    s_mov_b32 s7, 0x20000
    s_lshl_b32 s84, s80, 19
    s_add_u32 s8, s76, s84
    s_addc_u32 s9, s77, 0
    s_and_b32 s9, s9, 0xffff
    s_sub_u32 s10, 0x400000, s84
    s_mov_b32 s11, 0x20000
    s_mov_b32 s52, 0
    v_lshrrev_b32 v3, 3, v2
    v_lshrrev_b32 v4, 4, v2
    v_and_b32 v5, 7, v2
    s_mul_i32 s84, s54, 32
    v_add_u32 v6, 0, v4
    v_and_b32 v6, 7, v6
    v_xor_b32 v6, v6, v5
    v_add_u32 v7, 0, v3
    v_add_u32 v7, s84, v7
    v_lshlrev_b32 v7, 11, v7
    v_lshl_add_u32 v20, v6, 4, v7
    v_add_u32 v6, 4, v4
    v_and_b32 v6, 7, v6
    v_xor_b32 v6, v6, v5
    v_add_u32 v7, 8, v3
    v_add_u32 v7, s84, v7
    v_lshlrev_b32 v7, 11, v7
    v_lshl_add_u32 v21, v6, 4, v7
    v_add_u32 v6, 8, v4
    v_and_b32 v6, 7, v6
    v_xor_b32 v6, v6, v5
    v_add_u32 v7, 16, v3
    v_add_u32 v7, s84, v7
    v_lshlrev_b32 v7, 11, v7
    v_lshl_add_u32 v22, v6, 4, v7
    v_add_u32 v6, 12, v4
    v_and_b32 v6, 7, v6
    v_xor_b32 v6, v6, v5
    v_add_u32 v7, 24, v3
    v_add_u32 v7, s84, v7
    v_lshlrev_b32 v7, 11, v7
    v_lshl_add_u32 v23, v6, 4, v7
    s_and_b32 s84, s54, 3
    s_lshr_b32 s85, s54, 2
    s_mul_i32 s85, s85, 5
    s_lshl_b32 s86, s84, 4
    v_lshrrev_b32 v3, 2, v2
    v_add_u32 v28, s86, v3
    v_and_b32 v4, 3, v2
    v_lshrrev_b32 v5, 5, v2
    v_lshlrev_b32 v5, 1, v5
    v_xor_b32 v4, v4, v5
    v_lshlrev_b32 v29, 4, v4
    s_mul_i32 s86, s79, 10
    s_mul_i32 s56, s54, 4096
    s_add_u32 s57, s56, 32768
    s_lshl_b32 s58, s85, 12
    s_lshl_b32 s86, s84, 10
    s_add_u32 s58, s58, s86
    s_add_u32 s59, s58, 106496
    s_add_u32 s58, s58, 65536
    s_mul_i32 s86, s79, 10
    s_mov_b32 m0, s56
    s_nop 0
    buffer_load_dwordx4 v20, s[8:11], s52 offen lds
    s_add_u32 m0, m0, 0x400
    s_nop 0
    buffer_load_dwordx4 v21, s[8:11], s52 offen lds
    s_add_u32 m0, m0, 0x400
    s_nop 0
    buffer_load_dwordx4 v22, s[8:11], s52 offen lds
    s_add_u32 m0, m0, 0x400
    s_nop 0
    buffer_load_dwordx4 v23, s[8:11], s52 offen lds
    s_add_u32 m0, m0, 0x400
    s_nop 0
    s_add_u32 s52, s52, 128
    s_add_u32 s87, s85, 0
    s_add_u32 s88, s86, s87
    s_sub_u32 s89, s87, s82
    s_sub_u32 s90, s89, s81
    s_cmp_ge_u32 s89, s81
    s_cselect_b32 s89, s90, s89
    s_cselect_b32 s12, s74, s72
    s_cselect_b32 s13, s75, s73
    s_lshl_b32 s90, s89, 5
    s_add_u32 s90, s90, s83
    s_lshl_b32 s90, s90, 1
    s_lshl_b32 s89, s88, 6
    s_cmp_lt_u32 s88, 96
    s_cselect_b32 s90, s89, s90
    s_cselect_b32 s12, s70, s12
    s_cselect_b32 s13, s71, s13
    s_cselect_b32 s91, 6, 7
    s_lshl_b32 s91, s91, 26
    s_add_u32 s12, s12, s90
    s_addc_u32 s13, s13, 0
    s_and_b32 s13, s13, 0xffff
    s_or_b32 s13, s13, s91
    s_mov_b32 s14, 1024
    s_mov_b32 s15, 0x20000
    s_add_u32 m0, s58, 0
    s_nop 0
    buffer_load_dwordx4 v[28:29], s[12:15], 0 idxen offen lds
    s_add_u32 s87, s85, 1
    s_add_u32 s88, s86, s87
    s_sub_u32 s89, s87, s82
    s_sub_u32 s90, s89, s81
    s_cmp_ge_u32 s89, s81
    s_cselect_b32 s89, s90, s89
    s_cselect_b32 s16, s74, s72
    s_cselect_b32 s17, s75, s73
    s_lshl_b32 s90, s89, 5
    s_add_u32 s90, s90, s83
    s_lshl_b32 s90, s90, 1
    s_lshl_b32 s89, s88, 6
    s_cmp_lt_u32 s88, 96
    s_cselect_b32 s90, s89, s90
    s_cselect_b32 s16, s70, s16
    s_cselect_b32 s17, s71, s17
    s_cselect_b32 s91, 6, 7
    s_lshl_b32 s91, s91, 26
    s_add_u32 s16, s16, s90
    s_addc_u32 s17, s17, 0
    s_and_b32 s17, s17, 0xffff
    s_or_b32 s17, s17, s91
    s_mov_b32 s18, 1024
    s_mov_b32 s19, 0x20000
    s_add_u32 m0, s58, 4096
    s_nop 0
    buffer_load_dwordx4 v[28:29], s[16:19], 0 idxen offen lds
    s_add_u32 s87, s85, 2
    s_add_u32 s88, s86, s87
    s_sub_u32 s89, s87, s82
    s_sub_u32 s90, s89, s81
    s_cmp_ge_u32 s89, s81
    s_cselect_b32 s89, s90, s89
    s_cselect_b32 s20, s74, s72
    s_cselect_b32 s21, s75, s73
    s_lshl_b32 s90, s89, 5
    s_add_u32 s90, s90, s83
    s_lshl_b32 s90, s90, 1
    s_lshl_b32 s89, s88, 6
    s_cmp_lt_u32 s88, 96
    s_cselect_b32 s90, s89, s90
    s_cselect_b32 s20, s70, s20
    s_cselect_b32 s21, s71, s21
    s_cselect_b32 s91, 6, 7
    s_lshl_b32 s91, s91, 26
    s_add_u32 s20, s20, s90
    s_addc_u32 s21, s21, 0
    s_and_b32 s21, s21, 0xffff
    s_or_b32 s21, s21, s91
    s_mov_b32 s22, 1024
    s_mov_b32 s23, 0x20000
    s_add_u32 m0, s58, 8192
    s_nop 0
    buffer_load_dwordx4 v[28:29], s[20:23], 0 idxen offen lds
    s_add_u32 s87, s85, 3
    s_add_u32 s88, s86, s87
    s_sub_u32 s89, s87, s82
    s_sub_u32 s90, s89, s81
    s_cmp_ge_u32 s89, s81
    s_cselect_b32 s89, s90, s89
    s_cselect_b32 s24, s74, s72
    s_cselect_b32 s25, s75, s73
    s_lshl_b32 s90, s89, 5
    s_add_u32 s90, s90, s83
    s_lshl_b32 s90, s90, 1
    s_lshl_b32 s89, s88, 6
    s_cmp_lt_u32 s88, 96
    s_cselect_b32 s90, s89, s90
    s_cselect_b32 s24, s70, s24
    s_cselect_b32 s25, s71, s25
    s_cselect_b32 s91, 6, 7
    s_lshl_b32 s91, s91, 26
    s_add_u32 s24, s24, s90
    s_addc_u32 s25, s25, 0
    s_and_b32 s25, s25, 0xffff
    s_or_b32 s25, s25, s91
    s_mov_b32 s26, 1024
    s_mov_b32 s27, 0x20000
    s_add_u32 m0, s58, 12288
    s_nop 0
    buffer_load_dwordx4 v[28:29], s[24:27], 0 idxen offen lds
    s_add_u32 s87, s85, 4
    s_add_u32 s88, s86, s87
    s_sub_u32 s89, s87, s82
    s_sub_u32 s90, s89, s81
    s_cmp_ge_u32 s89, s81
    s_cselect_b32 s89, s90, s89
    s_cselect_b32 s28, s74, s72
    s_cselect_b32 s29, s75, s73
    s_lshl_b32 s90, s89, 5
    s_add_u32 s90, s90, s83
    s_lshl_b32 s90, s90, 1
    s_lshl_b32 s89, s88, 6
    s_cmp_lt_u32 s88, 96
    s_cselect_b32 s90, s89, s90
    s_cselect_b32 s28, s70, s28
    s_cselect_b32 s29, s71, s29
    s_cselect_b32 s91, 6, 7
    s_lshl_b32 s91, s91, 26
    s_add_u32 s28, s28, s90
    s_addc_u32 s29, s29, 0
    s_and_b32 s29, s29, 0xffff
    s_or_b32 s29, s29, s91
    s_mov_b32 s30, 1024
    s_mov_b32 s31, 0x20000
    s_add_u32 m0, s58, 16384
    s_nop 0
    buffer_load_dwordx4 v[28:29], s[28:31], 0 idxen offen lds
    v_add_u32 v28, 64, v28
    s_mov_b32 m0, s57
    s_nop 0
    buffer_load_dwordx4 v20, s[8:11], s52 offen lds
    s_add_u32 m0, m0, 0x400
    s_nop 0
    buffer_load_dwordx4 v21, s[8:11], s52 offen lds
    s_add_u32 m0, m0, 0x400
    s_nop 0
    buffer_load_dwordx4 v22, s[8:11], s52 offen lds
    s_add_u32 m0, m0, 0x400
    s_nop 0
    buffer_load_dwordx4 v23, s[8:11], s52 offen lds
    s_add_u32 m0, m0, 0x400
    s_nop 0
    s_add_u32 s52, s52, 128
    s_mov_b32 m0, s59
    s_nop 0
    buffer_load_dwordx4 v[28:29], s[12:15], 0 idxen offen lds
    s_add_u32 m0, m0, 0x1000
    s_nop 0
    buffer_load_dwordx4 v[28:29], s[16:19], 0 idxen offen lds
    s_add_u32 m0, m0, 0x1000
    s_nop 0
    buffer_load_dwordx4 v[28:29], s[20:23], 0 idxen offen lds
    s_add_u32 m0, m0, 0x1000
    s_nop 0
    buffer_load_dwordx4 v[28:29], s[24:27], 0 idxen offen lds
    s_add_u32 m0, m0, 0x1000
    s_nop 0
    buffer_load_dwordx4 v[28:29], s[28:31], 0 idxen offen lds
    s_add_u32 m0, m0, 0x1000
    s_nop 0
    v_add_u32 v28, 64, v28
    s_mul_i32 s86, s79, 10
    s_lshl_b32 s84, s54, 3
    s_add_u32 s84, s84, s80
    s_min_u32 s87, s84, 9
    s_add_u32 s88, s86, s87
    s_sub_u32 s89, s87, s82
    s_sub_u32 s90, s89, s81
    s_cmp_ge_u32 s89, s81
    s_cselect_b32 s89, s90, s89
    s_cselect_b32 s32, s74, s72
    s_cselect_b32 s33, s75, s73
    s_lshl_b32 s90, s89, 5
    s_add_u32 s90, s90, s83
    s_lshl_b32 s90, s90, 1
    s_lshl_b32 s89, s88, 6
    s_cmp_lt_u32 s88, 96
    s_cselect_b32 s90, s89, s90
    s_cselect_b32 s32, s70, s32
    s_cselect_b32 s33, s71, s33
    s_cselect_b32 s91, 6, 7
    s_lshl_b32 s91, s91, 26
    s_add_u32 s32, s32, s90
    s_addc_u32 s33, s33, 0
    s_and_b32 s33, s33, 0xffff
    s_or_b32 s33, s33, s91
    s_mov_b32 s34, 1024
    s_mov_b32 s35, 0x20000
    s_cmp_lt_u32 s84, 10
    s_cselect_b32 s34, 1024, 0
    v_add_u32 v24, 128, v2
    v_mov_b32 v25, 0
    s_cmp_lt_u32 s54, 2
    s_cbranch_scc1 L_g1_nopfw
    s_cmp_gt_u32 s54, 3
    s_cbranch_scc1 L_g1_nopfw
    s_mul_i32 s84, s2, 28672
    s_lshl_b32 s87, s2, 13
    s_cmp_eq_u32 s54, 2
    s_cselect_b32 s32, s44, s46
    s_cselect_b32 s33, s45, s47
    s_cselect_b32 s84, s84, s87
    s_cselect_b32 s34, 224, 64
    s_add_u32 s32, s32, s84
    s_addc_u32 s33, s33, 0
    s_and_b32 s33, s33, 0xffff
    s_or_b32 s33, s33, 8388608
    v_subrev_u32 v24, 256, v2
L_g1_nopfw:
    buffer_load_dword v26, v[24:25], s[32:35], 0 idxen offen
    v_add_u32 v24, 64, v24
    s_and_b32 s84, s54, 3
    s_lshr_b32 s85, s54, 2
    v_and_b32 v3, 15, v2
    v_lshrrev_b32 v4, 4, v2
    v_lshrrev_b32 v5, 1, v3
    s_mul_i32 s86, s84, 64
    v_add_u32 v6, s86, v3
    v_lshlrev_b32 v6, 7, v6
    v_add_u32 v7, 0, v4
    v_xor_b32 v7, v7, v5
    v_lshl_add_u32 v8, v7, 4, v6
    v_add_u32 v7, 4, v4
    v_xor_b32 v7, v7, v5
    v_lshl_add_u32 v9, v7, 4, v6
    v_lshrrev_b32 v5, 2, v2
    v_and_b32 v5, 3, v5
    v_lshl_add_u32 v5, v4, 3, v5
    v_lshlrev_b32 v5, 6, v5
    v_and_b32 v6, 3, v2
    v_lshl_add_u32 v5, v6, 3, v5
    v_add_u32 v5, 65536, v5
    v_and_b32 v6, 1, v4
    v_lshlrev_b32 v6, 5, v6
    s_mul_i32 s86, s79, 10
    s_mul_i32 s87, s85, 5
    s_add_u32 s88, s87, 0
    s_add_u32 s89, s86, s88
    s_sub_u32 s90, s88, s82
    s_and_b32 s93, s90, 1
    s_lshr_b32 s94, s90, 1
    s_add_u32 s94, s94, s82
    s_lshl_b32 s91, s94, 12
    s_add_u32 s94, s94, s81
    s_lshl_b32 s92, s94, 12
    s_lshl_b32 s94, s93, 5
    s_add_u32 s91, s91, s94
    s_add_u32 s92, s92, s94
    s_lshl_b32 s94, s90, 4
    s_add_u32 s94, s94, s83
    s_lshr_b32 s65, s94, 5
    s_lshl_b32 s65, s65, 10
    s_and_b32 s94, s94, 16
    s_lshl_b32 s94, s94, 5
    s_add_u32 s65, s65, s94
    s_add_u32 s65, s65, 41975808
    s_lshl_b32 s94, s89, 17
    s_add_u32 s94, s94, 4194304
    s_lshl_b32 s88, s88, 12
    s_add_u32 s93, s88, 32
    s_cmp_lt_u32 s89, 32
    s_cselect_b32 s60, 2, 1
    s_cmp_lt_u32 s89, 96
    s_cselect_b32 s60, s60, 0
    s_cselect_b32 s65, s94, s65
    s_cselect_b32 s91, s88, s91
    s_cselect_b32 s92, s93, s92
    v_xor_b32 v7, s91, v6
    v_add_u32 v10, v7, v5
    v_xor_b32 v7, s92, v6
    v_add_u32 v11, v7, v5
    s_add_u32 s88, s87, 1
    s_add_u32 s89, s86, s88
    s_sub_u32 s90, s88, s82
    s_and_b32 s93, s90, 1
    s_lshr_b32 s94, s90, 1
    s_add_u32 s94, s94, s82
    s_lshl_b32 s91, s94, 12
    s_add_u32 s94, s94, s81
    s_lshl_b32 s92, s94, 12
    s_lshl_b32 s94, s93, 5
    s_add_u32 s91, s91, s94
    s_add_u32 s92, s92, s94
    s_lshl_b32 s94, s90, 4
    s_add_u32 s94, s94, s83
    s_lshr_b32 s66, s94, 5
    s_lshl_b32 s66, s66, 10
    s_and_b32 s94, s94, 16
    s_lshl_b32 s94, s94, 5
    s_add_u32 s66, s66, s94
    s_add_u32 s66, s66, 41975808
    s_lshl_b32 s94, s89, 17
    s_add_u32 s94, s94, 4194304
    s_lshl_b32 s88, s88, 12
    s_add_u32 s93, s88, 32
    s_cmp_lt_u32 s89, 32
    s_cselect_b32 s61, 2, 1
    s_cmp_lt_u32 s89, 96
    s_cselect_b32 s61, s61, 0
    s_cselect_b32 s66, s94, s66
    s_cselect_b32 s91, s88, s91
    s_cselect_b32 s92, s93, s92
    v_xor_b32 v7, s91, v6
    v_add_u32 v12, v7, v5
    v_xor_b32 v7, s92, v6
    v_add_u32 v13, v7, v5
    s_add_u32 s88, s87, 2
    s_add_u32 s89, s86, s88
    s_sub_u32 s90, s88, s82
    s_and_b32 s93, s90, 1
    s_lshr_b32 s94, s90, 1
    s_add_u32 s94, s94, s82
    s_lshl_b32 s91, s94, 12
    s_add_u32 s94, s94, s81
    s_lshl_b32 s92, s94, 12
    s_lshl_b32 s94, s93, 5
    s_add_u32 s91, s91, s94
    s_add_u32 s92, s92, s94
    s_lshl_b32 s94, s90, 4
    s_add_u32 s94, s94, s83
    s_lshr_b32 s67, s94, 5
    s_lshl_b32 s67, s67, 10
    s_and_b32 s94, s94, 16
    s_lshl_b32 s94, s94, 5
    s_add_u32 s67, s67, s94
    s_add_u32 s67, s67, 41975808
    s_lshl_b32 s94, s89, 17
    s_add_u32 s94, s94, 4194304
    s_lshl_b32 s88, s88, 12
    s_add_u32 s93, s88, 32
    s_cmp_lt_u32 s89, 32
    s_cselect_b32 s62, 2, 1
    s_cmp_lt_u32 s89, 96
    s_cselect_b32 s62, s62, 0
    s_cselect_b32 s67, s94, s67
    s_cselect_b32 s91, s88, s91
    s_cselect_b32 s92, s93, s92
    v_xor_b32 v7, s91, v6
    v_add_u32 v14, v7, v5
    v_xor_b32 v7, s92, v6
    v_add_u32 v15, v7, v5
    s_add_u32 s88, s87, 3
    s_add_u32 s89, s86, s88
    s_sub_u32 s90, s88, s82
    s_and_b32 s93, s90, 1
    s_lshr_b32 s94, s90, 1
    s_add_u32 s94, s94, s82
    s_lshl_b32 s91, s94, 12
    s_add_u32 s94, s94, s81
    s_lshl_b32 s92, s94, 12
    s_lshl_b32 s94, s93, 5
    s_add_u32 s91, s91, s94
    s_add_u32 s92, s92, s94
    s_lshl_b32 s94, s90, 4
    s_add_u32 s94, s94, s83
    s_lshr_b32 s68, s94, 5
    s_lshl_b32 s68, s68, 10
    s_and_b32 s94, s94, 16
    s_lshl_b32 s94, s94, 5
    s_add_u32 s68, s68, s94
    s_add_u32 s68, s68, 41975808
    s_lshl_b32 s94, s89, 17
    s_add_u32 s94, s94, 4194304
    s_lshl_b32 s88, s88, 12
    s_add_u32 s93, s88, 32
    s_cmp_lt_u32 s89, 32
    s_cselect_b32 s63, 2, 1
    s_cmp_lt_u32 s89, 96
    s_cselect_b32 s63, s63, 0
    s_cselect_b32 s68, s94, s68
    s_cselect_b32 s91, s88, s91
    s_cselect_b32 s92, s93, s92
    v_xor_b32 v7, s91, v6
    v_add_u32 v16, v7, v5
    v_xor_b32 v7, s92, v6
    v_add_u32 v17, v7, v5
    s_add_u32 s88, s87, 4
    s_add_u32 s89, s86, s88
    s_sub_u32 s90, s88, s82
    s_and_b32 s93, s90, 1
    s_lshr_b32 s94, s90, 1
    s_add_u32 s94, s94, s82
    s_lshl_b32 s91, s94, 12
    s_add_u32 s94, s94, s81
    s_lshl_b32 s92, s94, 12
    s_lshl_b32 s94, s93, 5
    s_add_u32 s91, s91, s94
    s_add_u32 s92, s92, s94
    s_lshl_b32 s94, s90, 4
    s_add_u32 s94, s94, s83
    s_lshr_b32 s69, s94, 5
    s_lshl_b32 s69, s69, 10
    s_and_b32 s94, s94, 16
    s_lshl_b32 s94, s94, 5
    s_add_u32 s69, s69, s94
    s_add_u32 s69, s69, 41975808
    s_lshl_b32 s94, s89, 17
    s_add_u32 s94, s94, 4194304
    s_lshl_b32 s88, s88, 12
    s_add_u32 s93, s88, 32
    s_cmp_lt_u32 s89, 32
    s_cselect_b32 s64, 2, 1
    s_cmp_lt_u32 s89, 96
    s_cselect_b32 s64, s64, 0
    s_cselect_b32 s69, s94, s69
    s_cselect_b32 s91, s88, s91
    s_cselect_b32 s92, s93, s92
    v_xor_b32 v7, s91, v6
    v_add_u32 v18, v7, v5
    v_xor_b32 v7, s92, v6
    v_add_u32 v19, v7, v5
    s_waitcnt vmcnt(10)
    s_barrier
    ds_read_b128 v[32:35], v8 offset:0
    ds_read_b128 v[36:39], v8 offset:2048
    ds_read_b128 v[40:43], v8 offset:4096
    ds_read_b128 v[44:47], v8 offset:6144
    ds_read_b64_tr_b16 v[64:65], v10 offset:0
    ds_read_b64_tr_b16 v[66:67], v10 offset:256
    ds_read_b64_tr_b16 v[68:69], v11 offset:0
    ds_read_b64_tr_b16 v[70:71], v11 offset:256
    ds_read_b64_tr_b16 v[72:73], v12 offset:0
    ds_read_b64_tr_b16 v[74:75], v12 offset:256
    s_waitcnt lgkmcnt(4)
    v_mfma_f32_16x16x32_bf16 v[96:99], v[64:67], v[32:35], 0
    ds_read_b64_tr_b16 v[76:77], v13 offset:0
    v_mfma_f32_16x16x32_bf16 v[100:103], v[64:67], v[36:39], 0
    v_mfma_f32_16x16x32_bf16 v[104:107], v[64:67], v[40:43], 0
    ds_read_b64_tr_b16 v[78:79], v13 offset:256
    v_mfma_f32_16x16x32_bf16 v[108:111], v[64:67], v[44:47], 0
    s_waitcnt lgkmcnt(4)
    v_mfma_f32_16x16x32_bf16 v[112:115], v[68:71], v[32:35], 0
    ds_read_b64_tr_b16 v[64:65], v14 offset:0
    v_mfma_f32_16x16x32_bf16 v[116:119], v[68:71], v[36:39], 0
    ds_read_b64_tr_b16 v[66:67], v14 offset:256
    v_mfma_f32_16x16x32_bf16 v[120:123], v[68:71], v[40:43], 0
    ds_read_b128 v[48:51], v9 offset:0
    v_mfma_f32_16x16x32_bf16 v[124:127], v[68:71], v[44:47], 0
    s_waitcnt lgkmcnt(5)
    v_mfma_f32_16x16x32_bf16 v[128:131], v[72:75], v[32:35], 0
    ds_read_b64_tr_b16 v[68:69], v15 offset:0
    v_mfma_f32_16x16x32_bf16 v[132:135], v[72:75], v[36:39], 0
    v_mfma_f32_16x16x32_bf16 v[136:139], v[72:75], v[40:43], 0
    ds_read_b64_tr_b16 v[70:71], v15 offset:256
    v_mfma_f32_16x16x32_bf16 v[140:143], v[72:75], v[44:47], 0
    s_waitcnt lgkmcnt(5)
    v_mfma_f32_16x16x32_bf16 v[144:147], v[76:79], v[32:35], 0
    ds_read_b64_tr_b16 v[72:73], v16 offset:0
    v_mfma_f32_16x16x32_bf16 v[148:151], v[76:79], v[36:39], 0
    ds_read_b64_tr_b16 v[74:75], v16 offset:256
    v_mfma_f32_16x16x32_bf16 v[152:155], v[76:79], v[40:43], 0
    ds_read_b128 v[52:55], v9 offset:2048
    v_mfma_f32_16x16x32_bf16 v[156:159], v[76:79], v[44:47], 0
    s_waitcnt lgkmcnt(6)
    v_mfma_f32_16x16x32_bf16 v[160:163], v[64:67], v[32:35], 0
    ds_read_b64_tr_b16 v[76:77], v17 offset:0
    v_mfma_f32_16x16x32_bf16 v[164:167], v[64:67], v[36:39], 0
    v_mfma_f32_16x16x32_bf16 v[168:171], v[64:67], v[40:43], 0
    ds_read_b64_tr_b16 v[78:79], v17 offset:256
    v_mfma_f32_16x16x32_bf16 v[172:175], v[64:67], v[44:47], 0
    s_waitcnt lgkmcnt(5)
    v_mfma_f32_16x16x32_bf16 v[176:179], v[68:71], v[32:35], 0
    ds_read_b64_tr_b16 v[64:65], v18 offset:0
    v_mfma_f32_16x16x32_bf16 v[180:183], v[68:71], v[36:39], 0
    ds_read_b64_tr_b16 v[66:67], v18 offset:256
    v_mfma_f32_16x16x32_bf16 v[184:187], v[68:71], v[40:43], 0
    ds_read_b128 v[56:59], v9 offset:4096
    v_mfma_f32_16x16x32_bf16 v[188:191], v[68:71], v[44:47], 0
    s_waitcnt lgkmcnt(6)
    v_mfma_f32_16x16x32_bf16 v[192:195], v[72:75], v[32:35], 0
    ds_read_b64_tr_b16 v[68:69], v19 offset:0
    v_mfma_f32_16x16x32_bf16 v[196:199], v[72:75], v[36:39], 0
    v_mfma_f32_16x16x32_bf16 v[200:203], v[72:75], v[40:43], 0
    ds_read_b64_tr_b16 v[70:71], v19 offset:256
    v_mfma_f32_16x16x32_bf16 v[204:207], v[72:75], v[44:47], 0
    s_waitcnt lgkmcnt(5)
    v_mfma_f32_16x16x32_bf16 v[208:211], v[76:79], v[32:35], 0
    ds_read_b64_tr_b16 v[72:73], v10 offset:2048
    v_mfma_f32_16x16x32_bf16 v[212:215], v[76:79], v[36:39], 0
    ds_read_b64_tr_b16 v[74:75], v10 offset:2304
    v_mfma_f32_16x16x32_bf16 v[216:219], v[76:79], v[40:43], 0
    ds_read_b128 v[60:63], v9 offset:6144
    v_mfma_f32_16x16x32_bf16 v[220:223], v[76:79], v[44:47], 0
    s_waitcnt lgkmcnt(6)
    v_mfma_f32_16x16x32_bf16 v[224:227], v[64:67], v[32:35], 0
    ds_read_b64_tr_b16 v[76:77], v11 offset:2048
    v_mfma_f32_16x16x32_bf16 v[228:231], v[64:67], v[36:39], 0
    v_mfma_f32_16x16x32_bf16 v[232:235], v[64:67], v[40:43], 0
    ds_read_b64_tr_b16 v[78:79], v11 offset:2304
    v_mfma_f32_16x16x32_bf16 v[236:239], v[64:67], v[44:47], 0
    s_waitcnt lgkmcnt(5)
    v_mfma_f32_16x16x32_bf16 v[240:243], v[68:71], v[32:35], 0
    ds_read_b64_tr_b16 v[64:65], v12 offset:2048
    v_mfma_f32_16x16x32_bf16 v[244:247], v[68:71], v[36:39], 0
    v_mfma_f32_16x16x32_bf16 v[248:251], v[68:71], v[40:43], 0
    ds_read_b64_tr_b16 v[66:67], v12 offset:2304
    v_mfma_f32_16x16x32_bf16 v[252:255], v[68:71], v[44:47], 0
    s_waitcnt lgkmcnt(4)
    v_mfma_f32_16x16x32_bf16 v[96:99], v[72:75], v[48:51], v[96:99]
    ds_read_b64_tr_b16 v[68:69], v13 offset:2048
    v_mfma_f32_16x16x32_bf16 v[100:103], v[72:75], v[52:55], v[100:103]
    v_mfma_f32_16x16x32_bf16 v[104:107], v[72:75], v[56:59], v[104:107]
    ds_read_b64_tr_b16 v[70:71], v13 offset:2304
    v_mfma_f32_16x16x32_bf16 v[108:111], v[72:75], v[60:63], v[108:111]
    s_waitcnt lgkmcnt(4)
    v_mfma_f32_16x16x32_bf16 v[112:115], v[76:79], v[48:51], v[112:115]
    ds_read_b64_tr_b16 v[72:73], v14 offset:2048
    v_mfma_f32_16x16x32_bf16 v[116:119], v[76:79], v[52:55], v[116:119]
    v_mfma_f32_16x16x32_bf16 v[120:123], v[76:79], v[56:59], v[120:123]
    ds_read_b64_tr_b16 v[74:75], v14 offset:2304
    v_mfma_f32_16x16x32_bf16 v[124:127], v[76:79], v[60:63], v[124:127]
    s_waitcnt lgkmcnt(4)
    v_mfma_f32_16x16x32_bf16 v[128:131], v[64:67], v[48:51], v[128:131]
    ds_read_b64_tr_b16 v[76:77], v15 offset:2048
    v_mfma_f32_16x16x32_bf16 v[132:135], v[64:67], v[52:55], v[132:135]
    v_mfma_f32_16x16x32_bf16 v[136:139], v[64:67], v[56:59], v[136:139]
    ds_read_b64_tr_b16 v[78:79], v15 offset:2304
    v_mfma_f32_16x16x32_bf16 v[140:143], v[64:67], v[60:63], v[140:143]
    s_waitcnt lgkmcnt(4)
    v_mfma_f32_16x16x32_bf16 v[144:147], v[68:71], v[48:51], v[144:147]
    ds_read_b64_tr_b16 v[64:65], v16 offset:2048
    v_mfma_f32_16x16x32_bf16 v[148:151], v[68:71], v[52:55], v[148:151]
    v_mfma_f32_16x16x32_bf16 v[152:155], v[68:71], v[56:59], v[152:155]
    ds_read_b64_tr_b16 v[66:67], v16 offset:2304
    v_mfma_f32_16x16x32_bf16 v[156:159], v[68:71], v[60:63], v[156:159]
    s_waitcnt lgkmcnt(4)
    v_mfma_f32_16x16x32_bf16 v[160:163], v[72:75], v[48:51], v[160:163]
    ds_read_b64_tr_b16 v[68:69], v17 offset:2048
    v_mfma_f32_16x16x32_bf16 v[164:167], v[72:75], v[52:55], v[164:167]
    v_mfma_f32_16x16x32_bf16 v[168:171], v[72:75], v[56:59], v[168:171]
    ds_read_b64_tr_b16 v[70:71], v17 offset:2304
    v_mfma_f32_16x16x32_bf16 v[172:175], v[72:75], v[60:63], v[172:175]
    s_waitcnt lgkmcnt(4)
    v_mfma_f32_16x16x32_bf16 v[176:179], v[76:79], v[48:51], v[176:179]
    ds_read_b64_tr_b16 v[72:73], v18 offset:2048
    v_mfma_f32_16x16x32_bf16 v[180:183], v[76:79], v[52:55], v[180:183]
    v_mfma_f32_16x16x32_bf16 v[184:187], v[76:79], v[56:59], v[184:187]
    ds_read_b64_tr_b16 v[74:75], v18 offset:2304
    v_mfma_f32_16x16x32_bf16 v[188:191], v[76:79], v[60:63], v[188:191]
    s_waitcnt lgkmcnt(4)
    v_mfma_f32_16x16x32_bf16 v[192:195], v[64:67], v[48:51], v[192:195]
    ds_read_b64_tr_b16 v[76:77], v19 offset:2048
    v_mfma_f32_16x16x32_bf16 v[196:199], v[64:67], v[52:55], v[196:199]
    v_mfma_f32_16x16x32_bf16 v[200:203], v[64:67], v[56:59], v[200:203]
    ds_read_b64_tr_b16 v[78:79], v19 offset:2304
    v_mfma_f32_16x16x32_bf16 v[204:207], v[64:67], v[60:63], v[204:207]
    s_waitcnt vmcnt(1) lgkmcnt(0)
    s_barrier
    s_mov_b32 s53, 7
L_g1_loop:
    v_mfma_f32_16x16x32_bf16 v[208:211], v[68:71], v[48:51], v[208:211]
    ds_read_b64_tr_b16 v[64:65], v10 offset:40960
    ds_read_b64_tr_b16 v[66:67], v10 offset:41216
    v_mfma_f32_16x16x32_bf16 v[212:215], v[68:71], v[52:55], v[212:215]
    ds_read_b128 v[32:35], v8 offset:32768
    v_mfma_f32_16x16x32_bf16 v[216:219], v[68:71], v[56:59], v[216:219]
    s_mov_b32 m0, s56
    v_mfma_f32_16x16x32_bf16 v[220:223], v[68:71], v[60:63], v[220:223]
    buffer_load_dwordx4 v20, s[8:11], s52 offen lds
    s_add_u32 m0, m0, 0x400
    v_mfma_f32_16x16x32_bf16 v[224:227], v[72:75], v[48:51], v[224:227]
    ds_read_b64_tr_b16 v[68:69], v11 offset:40960
    v_mfma_f32_16x16x32_bf16 v[228:231], v[72:75], v[52:55], v[228:231]
    ds_read_b64_tr_b16 v[70:71], v11 offset:41216
    v_mfma_f32_16x16x32_bf16 v[232:235], v[72:75], v[56:59], v[232:235]
    ds_read_b128 v[36:39], v8 offset:34816
    v_mfma_f32_16x16x32_bf16 v[236:239], v[72:75], v[60:63], v[236:239]
    buffer_load_dwordx4 v21, s[8:11], s52 offen lds
    s_add_u32 m0, m0, 0x400
    v_mfma_f32_16x16x32_bf16 v[240:243], v[76:79], v[48:51], v[240:243]
    ds_read_b64_tr_b16 v[72:73], v12 offset:40960
    ds_read_b64_tr_b16 v[74:75], v12 offset:41216
    v_mfma_f32_16x16x32_bf16 v[244:247], v[76:79], v[52:55], v[244:247]
    ds_read_b128 v[40:43], v8 offset:36864
    v_mfma_f32_16x16x32_bf16 v[248:251], v[76:79], v[56:59], v[248:251]
    ds_read_b128 v[44:47], v8 offset:38912
    v_mfma_f32_16x16x32_bf16 v[252:255], v[76:79], v[60:63], v[252:255]
    buffer_load_dwordx4 v22, s[8:11], s52 offen lds
    s_add_u32 m0, m0, 0x400
    s_waitcnt lgkmcnt(0)
    v_mfma_f32_16x16x32_bf16 v[96:99], v[64:67], v[32:35], v[96:99]
    ds_read_b64_tr_b16 v[76:77], v13 offset:40960
    v_mfma_f32_16x16x32_bf16 v[100:103], v[64:67], v[36:39], v[100:103]
    ds_read_b64_tr_b16 v[78:79], v13 offset:41216
    v_mfma_f32_16x16x32_bf16 v[104:107], v[64:67], v[40:43], v[104:107]
    buffer_load_dwordx4 v23, s[8:11], s52 offen lds
    s_mov_b32 m0, s58
    v_mfma_f32_16x16x32_bf16 v[108:111], v[64:67], v[44:47], v[108:111]
    v_mfma_f32_16x16x32_bf16 v[112:115], v[68:71], v[32:35], v[112:115]
    ds_read_b64_tr_b16 v[64:65], v14 offset:40960
    v_mfma_f32_16x16x32_bf16 v[116:119], v[68:71], v[36:39], v[116:119]
    ds_read_b64_tr_b16 v[66:67], v14 offset:41216
    v_mfma_f32_16x16x32_bf16 v[120:123], v[68:71], v[40:43], v[120:123]
    ds_read_b128 v[48:51], v9 offset:32768
    v_mfma_f32_16x16x32_bf16 v[124:127], v[68:71], v[44:47], v[124:127]
    buffer_load_dwordx4 v[28:29], s[12:15], 0 idxen offen lds
    s_add_u32 m0, m0, 0x1000
    v_mfma_f32_16x16x32_bf16 v[128:131], v[72:75], v[32:35], v[128:131]
    ds_read_b64_tr_b16 v[68:69], v15 offset:40960
    v_mfma_f32_16x16x32_bf16 v[132:135], v[72:75], v[36:39], v[132:135]
    ds_read_b64_tr_b16 v[70:71], v15 offset:41216
    v_mfma_f32_16x16x32_bf16 v[136:139], v[72:75], v[40:43], v[136:139]
    buffer_load_dwordx4 v[28:29], s[16:19], 0 idxen offen lds
    s_add_u32 m0, m0, 0x1000
    v_mfma_f32_16x16x32_bf16 v[140:143], v[72:75], v[44:47], v[140:143]
    buffer_load_dwordx4 v[28:29], s[20:23], 0 idxen offen lds
    s_add_u32 m0, m0, 0x1000
    s_waitcnt lgkmcnt(5)
    v_mfma_f32_16x16x32_bf16 v[144:147], v[76:79], v[32:35], v[144:147]
    ds_read_b64_tr_b16 v[72:73], v16 offset:40960
    v_mfma_f32_16x16x32_bf16 v[148:151], v[76:79], v[36:39], v[148:151]
    ds_read_b64_tr_b16 v[74:75], v16 offset:41216
    v_mfma_f32_16x16x32_bf16 v[152:155], v[76:79], v[40:43], v[152:155]
    ds_read_b128 v[52:55], v9 offset:34816
    v_mfma_f32_16x16x32_bf16 v[156:159], v[76:79], v[44:47], v[156:159]
    buffer_load_dwordx4 v[28:29], s[24:27], 0 idxen offen lds
    s_add_u32 m0, m0, 0x1000
    s_waitcnt lgkmcnt(6)
    v_mfma_f32_16x16x32_bf16 v[160:163], v[64:67], v[32:35], v[160:163]
    ds_read_b64_tr_b16 v[76:77], v17 offset:40960
    v_mfma_f32_16x16x32_bf16 v[164:167], v[64:67], v[36:39], v[164:167]
    ds_read_b64_tr_b16 v[78:79], v17 offset:41216
    v_mfma_f32_16x16x32_bf16 v[168:171], v[64:67], v[40:43], v[168:171]
    buffer_load_dwordx4 v[28:29], s[28:31], 0 idxen offen lds
    s_add_u32 m0, m0, 0x1000
    v_mfma_f32_16x16x32_bf16 v[172:175], v[64:67], v[44:47], v[172:175]
    s_waitcnt lgkmcnt(5)
    v_mfma_f32_16x16x32_bf16 v[176:179], v[68:71], v[32:35], v[176:179]
    ds_read_b64_tr_b16 v[64:65], v18 offset:40960
    v_mfma_f32_16x16x32_bf16 v[180:183], v[68:71], v[36:39], v[180:183]
    ds_read_b64_tr_b16 v[66:67], v18 offset:41216
    v_mfma_f32_16x16x32_bf16 v[184:187], v[68:71], v[40:43], v[184:187]
    ds_read_b128 v[56:59], v9 offset:36864
    v_mfma_f32_16x16x32_bf16 v[188:191], v[68:71], v[44:47], v[188:191]
    s_add_u32 s52, s52, 128
    v_add_u32 v28, 64, v28
    s_waitcnt lgkmcnt(6)
    v_mfma_f32_16x16x32_bf16 v[192:195], v[72:75], v[32:35], v[192:195]
    ds_read_b64_tr_b16 v[68:69], v19 offset:40960
    v_mfma_f32_16x16x32_bf16 v[196:199], v[72:75], v[36:39], v[196:199]
    ds_read_b64_tr_b16 v[70:71], v19 offset:41216
    v_mfma_f32_16x16x32_bf16 v[200:203], v[72:75], v[40:43], v[200:203]
    buffer_load_dword v26, v[24:25], s[32:35], 0 idxen offen
    v_add_u32 v24, 64, v24
    v_mfma_f32_16x16x32_bf16 v[204:207], v[72:75], v[44:47], v[204:207]
    s_waitcnt lgkmcnt(5)
    v_mfma_f32_16x16x32_bf16 v[208:211], v[76:79], v[32:35], v[208:211]
    ds_read_b64_tr_b16 v[72:73], v10 offset:43008
    v_mfma_f32_16x16x32_bf16 v[212:215], v[76:79], v[36:39], v[212:215]
    ds_read_b64_tr_b16 v[74:75], v10 offset:43264
    v_mfma_f32_16x16x32_bf16 v[216:219], v[76:79], v[40:43], v[216:219]
    ds_read_b128 v[60:63], v9 offset:38912
    v_mfma_f32_16x16x32_bf16 v[220:223], v[76:79], v[44:47], v[220:223]
    s_waitcnt lgkmcnt(6)
    v_mfma_f32_16x16x32_bf16 v[224:227], v[64:67], v[32:35], v[224:227]
    ds_read_b64_tr_b16 v[76:77], v11 offset:43008
    v_mfma_f32_16x16x32_bf16 v[228:231], v[64:67], v[36:39], v[228:231]
    v_mfma_f32_16x16x32_bf16 v[232:235], v[64:67], v[40:43], v[232:235]
    ds_read_b64_tr_b16 v[78:79], v11 offset:43264
    v_mfma_f32_16x16x32_bf16 v[236:239], v[64:67], v[44:47], v[236:239]
    s_waitcnt lgkmcnt(5)
    v_mfma_f32_16x16x32_bf16 v[240:243], v[68:71], v[32:35], v[240:243]
    ds_read_b64_tr_b16 v[64:65], v12 offset:43008
    v_mfma_f32_16x16x32_bf16 v[244:247], v[68:71], v[36:39], v[244:247]
    v_mfma_f32_16x16x32_bf16 v[248:251], v[68:71], v[40:43], v[248:251]
    ds_read_b64_tr_b16 v[66:67], v12 offset:43264
    v_mfma_f32_16x16x32_bf16 v[252:255], v[68:71], v[44:47], v[252:255]
    s_waitcnt lgkmcnt(4)
    v_mfma_f32_16x16x32_bf16 v[96:99], v[72:75], v[48:51], v[96:99]
    ds_read_b64_tr_b16 v[68:69], v13 offset:43008
    v_mfma_f32_16x16x32_bf16 v[100:103], v[72:75], v[52:55], v[100:103]
    v_mfma_f32_16x16x32_bf16 v[104:107], v[72:75], v[56:59], v[104:107]
    ds_read_b64_tr_b16 v[70:71], v13 offset:43264
    v_mfma_f32_16x16x32_bf16 v[108:111], v[72:75], v[60:63], v[108:111]
    s_waitcnt lgkmcnt(4)
    v_mfma_f32_16x16x32_bf16 v[112:115], v[76:79], v[48:51], v[112:115]
    ds_read_b64_tr_b16 v[72:73], v14 offset:43008
    v_mfma_f32_16x16x32_bf16 v[116:119], v[76:79], v[52:55], v[116:119]
    v_mfma_f32_16x16x32_bf16 v[120:123], v[76:79], v[56:59], v[120:123]
    ds_read_b64_tr_b16 v[74:75], v14 offset:43264
    v_mfma_f32_16x16x32_bf16 v[124:127], v[76:79], v[60:63], v[124:127]
    s_waitcnt lgkmcnt(4)
    v_mfma_f32_16x16x32_bf16 v[128:131], v[64:67], v[48:51], v[128:131]
    ds_read_b64_tr_b16 v[76:77], v15 offset:43008
    v_mfma_f32_16x16x32_bf16 v[132:135], v[64:67], v[52:55], v[132:135]
    v_mfma_f32_16x16x32_bf16 v[136:139], v[64:67], v[56:59], v[136:139]
    ds_read_b64_tr_b16 v[78:79], v15 offset:43264
    v_mfma_f32_16x16x32_bf16 v[140:143], v[64:67], v[60:63], v[140:143]
    s_waitcnt lgkmcnt(4)
    v_mfma_f32_16x16x32_bf16 v[144:147], v[68:71], v[48:51], v[144:147]
    ds_read_b64_tr_b16 v[64:65], v16 offset:43008
    v_mfma_f32_16x16x32_bf16 v[148:151], v[68:71], v[52:55], v[148:151]
    v_mfma_f32_16x16x32_bf16 v[152:155], v[68:71], v[56:59], v[152:155]
    ds_read_b64_tr_b16 v[66:67], v16 offset:43264
    v_mfma_f32_16x16x32_bf16 v[156:159], v[68:71], v[60:63], v[156:159]
    s_waitcnt lgkmcnt(4)
    v_mfma_f32_16x16x32_bf16 v[160:163], v[72:75], v[48:51], v[160:163]
    ds_read_b64_tr_b16 v[68:69], v17 offset:43008
    v_mfma_f32_16x16x32_bf16 v[164:167], v[72:75], v[52:55], v[164:167]
    v_mfma_f32_16x16x32_bf16 v[168:171], v[72:75], v[56:59], v[168:171]
    ds_read_b64_tr_b16 v[70:71], v17 offset:43264
    v_mfma_f32_16x16x32_bf16 v[172:175], v[72:75], v[60:63], v[172:175]
    s_waitcnt lgkmcnt(4)
    v_mfma_f32_16x16x32_bf16 v[176:179], v[76:79], v[48:51], v[176:179]
    ds_read_b64_tr_b16 v[72:73], v18 offset:43008
    v_mfma_f32_16x16x32_bf16 v[180:183], v[76:79], v[52:55], v[180:183]
    v_mfma_f32_16x16x32_bf16 v[184:187], v[76:79], v[56:59], v[184:187]
    ds_read_b64_tr_b16 v[74:75], v18 offset:43264
    v_mfma_f32_16x16x32_bf16 v[188:191], v[76:79], v[60:63], v[188:191]
    s_waitcnt lgkmcnt(4)
    v_mfma_f32_16x16x32_bf16 v[192:195], v[64:67], v[48:51], v[192:195]
    ds_read_b64_tr_b16 v[76:77], v19 offset:43008
    v_mfma_f32_16x16x32_bf16 v[196:199], v[64:67], v[52:55], v[196:199]
    v_mfma_f32_16x16x32_bf16 v[200:203], v[64:67], v[56:59], v[200:203]
    ds_read_b64_tr_b16 v[78:79], v19 offset:43264
    v_mfma_f32_16x16x32_bf16 v[204:207], v[64:67], v[60:63], v[204:207]
    s_waitcnt vmcnt(1) lgkmcnt(0)
    s_barrier
    v_mfma_f32_16x16x32_bf16 v[208:211], v[68:71], v[48:51], v[208:211]
    ds_read_b64_tr_b16 v[64:65], v10 offset:0
    ds_read_b64_tr_b16 v[66:67], v10 offset:256
    v_mfma_f32_16x16x32_bf16 v[212:215], v[68:71], v[52:55], v[212:215]
    ds_read_b128 v[32:35], v8 offset:0
    v_mfma_f32_16x16x32_bf16 v[216:219], v[68:71], v[56:59], v[216:219]
    s_mov_b32 m0, s57
    v_mfma_f32_16x16x32_bf16 v[220:223], v[68:71], v[60:63], v[220:223]
    buffer_load_dwordx4 v20, s[8:11], s52 offen lds
    s_add_u32 m0, m0, 0x400
    v_mfma_f32_16x16x32_bf16 v[224:227], v[72:75], v[48:51], v[224:227]
    ds_read_b64_tr_b16 v[68:69], v11 offset:0
    v_mfma_f32_16x16x32_bf16 v[228:231], v[72:75], v[52:55], v[228:231]
    ds_read_b64_tr_b16 v[70:71], v11 offset:256
    v_mfma_f32_16x16x32_bf16 v[232:235], v[72:75], v[56:59], v[232:235]
    ds_read_b128 v[36:39], v8 offset:2048
    v_mfma_f32_16x16x32_bf16 v[236:239], v[72:75], v[60:63], v[236:239]
    buffer_load_dwordx4 v21, s[8:11], s52 offen lds
    s_add_u32 m0, m0, 0x400
    v_mfma_f32_16x16x32_bf16 v[240:243], v[76:79], v[48:51], v[240:243]
    ds_read_b64_tr_b16 v[72:73], v12 offset:0
    ds_read_b64_tr_b16 v[74:75], v12 offset:256
    v_mfma_f32_16x16x32_bf16 v[244:247], v[76:79], v[52:55], v[244:247]
    ds_read_b128 v[40:43], v8 offset:4096
    v_mfma_f32_16x16x32_bf16 v[248:251], v[76:79], v[56:59], v[248:251]
    ds_read_b128 v[44:47], v8 offset:6144
    v_mfma_f32_16x16x32_bf16 v[252:255], v[76:79], v[60:63], v[252:255]
    buffer_load_dwordx4 v22, s[8:11], s52 offen lds
    s_add_u32 m0, m0, 0x400
    s_waitcnt lgkmcnt(0)
    v_mfma_f32_16x16x32_bf16 v[96:99], v[64:67], v[32:35], v[96:99]
    ds_read_b64_tr_b16 v[76:77], v13 offset:0
    v_mfma_f32_16x16x32_bf16 v[100:103], v[64:67], v[36:39], v[100:103]
    ds_read_b64_tr_b16 v[78:79], v13 offset:256
    v_mfma_f32_16x16x32_bf16 v[104:107], v[64:67], v[40:43], v[104:107]
    buffer_load_dwordx4 v23, s[8:11], s52 offen lds
    s_mov_b32 m0, s59
    v_mfma_f32_16x16x32_bf16 v[108:111], v[64:67], v[44:47], v[108:111]
    v_mfma_f32_16x16x32_bf16 v[112:115], v[68:71], v[32:35], v[112:115]
    ds_read_b64_tr_b16 v[64:65], v14 offset:0
    v_mfma_f32_16x16x32_bf16 v[116:119], v[68:71], v[36:39], v[116:119]
    ds_read_b64_tr_b16 v[66:67], v14 offset:256
    v_mfma_f32_16x16x32_bf16 v[120:123], v[68:71], v[40:43], v[120:123]
    ds_read_b128 v[48:51], v9 offset:0
    v_mfma_f32_16x16x32_bf16 v[124:127], v[68:71], v[44:47], v[124:127]
    buffer_load_dwordx4 v[28:29], s[12:15], 0 idxen offen lds
    s_add_u32 m0, m0, 0x1000
    v_mfma_f32_16x16x32_bf16 v[128:131], v[72:75], v[32:35], v[128:131]
    ds_read_b64_tr_b16 v[68:69], v15 offset:0
    v_mfma_f32_16x16x32_bf16 v[132:135], v[72:75], v[36:39], v[132:135]
    ds_read_b64_tr_b16 v[70:71], v15 offset:256
    v_mfma_f32_16x16x32_bf16 v[136:139], v[72:75], v[40:43], v[136:139]
    buffer_load_dwordx4 v[28:29], s[16:19], 0 idxen offen lds
    s_add_u32 m0, m0, 0x1000
    v_mfma_f32_16x16x32_bf16 v[140:143], v[72:75], v[44:47], v[140:143]
    buffer_load_dwordx4 v[28:29], s[20:23], 0 idxen offen lds
    s_add_u32 m0, m0, 0x1000
    s_waitcnt lgkmcnt(5)
    v_mfma_f32_16x16x32_bf16 v[144:147], v[76:79], v[32:35], v[144:147]
    ds_read_b64_tr_b16 v[72:73], v16 offset:0
    v_mfma_f32_16x16x32_bf16 v[148:151], v[76:79], v[36:39], v[148:151]
    ds_read_b64_tr_b16 v[74:75], v16 offset:256
    v_mfma_f32_16x16x32_bf16 v[152:155], v[76:79], v[40:43], v[152:155]
    ds_read_b128 v[52:55], v9 offset:2048
    v_mfma_f32_16x16x32_bf16 v[156:159], v[76:79], v[44:47], v[156:159]
    buffer_load_dwordx4 v[28:29], s[24:27], 0 idxen offen lds
    s_add_u32 m0, m0, 0x1000
    s_waitcnt lgkmcnt(6)
    v_mfma_f32_16x16x32_bf16 v[160:163], v[64:67], v[32:35], v[160:163]
    ds_read_b64_tr_b16 v[76:77], v17 offset:0
    v_mfma_f32_16x16x32_bf16 v[164:167], v[64:67], v[36:39], v[164:167]
    ds_read_b64_tr_b16 v[78:79], v17 offset:256
    v_mfma_f32_16x16x32_bf16 v[168:171], v[64:67], v[40:43], v[168:171]
    buffer_load_dwordx4 v[28:29], s[28:31], 0 idxen offen lds
    s_add_u32 m0, m0, 0x1000
    v_mfma_f32_16x16x32_bf16 v[172:175], v[64:67], v[44:47], v[172:175]
    s_waitcnt lgkmcnt(5)
    v_mfma_f32_16x16x32_bf16 v[176:179], v[68:71], v[32:35], v[176:179]
    ds_read_b64_tr_b16 v[64:65], v18 offset:0
    v_mfma_f32_16x16x32_bf16 v[180:183], v[68:71], v[36:39], v[180:183]
    ds_read_b64_tr_b16 v[66:67], v18 offset:256
    v_mfma_f32_16x16x32_bf16 v[184:187], v[68:71], v[40:43], v[184:187]
    ds_read_b128 v[56:59], v9 offset:4096
    v_mfma_f32_16x16x32_bf16 v[188:191], v[68:71], v[44:47], v[188:191]
    s_add_u32 s52, s52, 128
    v_add_u32 v28, 64, v28
    s_waitcnt lgkmcnt(6)
    v_mfma_f32_16x16x32_bf16 v[192:195], v[72:75], v[32:35], v[192:195]
    ds_read_b64_tr_b16 v[68:69], v19 offset:0
    v_mfma_f32_16x16x32_bf16 v[196:199], v[72:75], v[36:39], v[196:199]
    ds_read_b64_tr_b16 v[70:71], v19 offset:256
    v_mfma_f32_16x16x32_bf16 v[200:203], v[72:75], v[40:43], v[200:203]
    buffer_load_dword v26, v[24:25], s[32:35], 0 idxen offen
    v_add_u32 v24, 64, v24
    v_mfma_f32_16x16x32_bf16 v[204:207], v[72:75], v[44:47], v[204:207]
    s_waitcnt lgkmcnt(5)
    v_mfma_f32_16x16x32_bf16 v[208:211], v[76:79], v[32:35], v[208:211]
    ds_read_b64_tr_b16 v[72:73], v10 offset:2048
    v_mfma_f32_16x16x32_bf16 v[212:215], v[76:79], v[36:39], v[212:215]
    ds_read_b64_tr_b16 v[74:75], v10 offset:2304
    v_mfma_f32_16x16x32_bf16 v[216:219], v[76:79], v[40:43], v[216:219]
    ds_read_b128 v[60:63], v9 offset:6144
    v_mfma_f32_16x16x32_bf16 v[220:223], v[76:79], v[44:47], v[220:223]
    s_waitcnt lgkmcnt(6)
    v_mfma_f32_16x16x32_bf16 v[224:227], v[64:67], v[32:35], v[224:227]
    ds_read_b64_tr_b16 v[76:77], v11 offset:2048
    v_mfma_f32_16x16x32_bf16 v[228:231], v[64:67], v[36:39], v[228:231]
    v_mfma_f32_16x16x32_bf16 v[232:235], v[64:67], v[40:43], v[232:235]
    ds_read_b64_tr_b16 v[78:79], v11 offset:2304
    v_mfma_f32_16x16x32_bf16 v[236:239], v[64:67], v[44:47], v[236:239]
    s_waitcnt lgkmcnt(5)
    v_mfma_f32_16x16x32_bf16 v[240:243], v[68:71], v[32:35], v[240:243]
    ds_read_b64_tr_b16 v[64:65], v12 offset:2048
    v_mfma_f32_16x16x32_bf16 v[244:247], v[68:71], v[36:39], v[244:247]
    v_mfma_f32_16x16x32_bf16 v[248:251], v[68:71], v[40:43], v[248:251]
    ds_read_b64_tr_b16 v[66:67], v12 offset:2304
    v_mfma_f32_16x16x32_bf16 v[252:255], v[68:71], v[44:47], v[252:255]
    s_waitcnt lgkmcnt(4)
    v_mfma_f32_16x16x32_bf16 v[96:99], v[72:75], v[48:51], v[96:99]
    ds_read_b64_tr_b16 v[68:69], v13 offset:2048
    v_mfma_f32_16x16x32_bf16 v[100:103], v[72:75], v[52:55], v[100:103]
    v_mfma_f32_16x16x32_bf16 v[104:107], v[72:75], v[56:59], v[104:107]
    ds_read_b64_tr_b16 v[70:71], v13 offset:2304
    v_mfma_f32_16x16x32_bf16 v[108:111], v[72:75], v[60:63], v[108:111]
    s_waitcnt lgkmcnt(4)
    v_mfma_f32_16x16x32_bf16 v[112:115], v[76:79], v[48:51], v[112:115]
    ds_read_b64_tr_b16 v[72:73], v14 offset:2048
    v_mfma_f32_16x16x32_bf16 v[116:119], v[76:79], v[52:55], v[116:119]
    v_mfma_f32_16x16x32_bf16 v[120:123], v[76:79], v[56:59], v[120:123]
    ds_read_b64_tr_b16 v[74:75], v14 offset:2304
    v_mfma_f32_16x16x32_bf16 v[124:127], v[76:79], v[60:63], v[124:127]
    s_waitcnt lgkmcnt(4)
    v_mfma_f32_16x16x32_bf16 v[128:131], v[64:67], v[48:51], v[128:131]
    ds_read_b64_tr_b16 v[76:77], v15 offset:2048
    v_mfma_f32_16x16x32_bf16 v[132:135], v[64:67], v[52:55], v[132:135]
    v_mfma_f32_16x16x32_bf16 v[136:139], v[64:67], v[56:59], v[136:139]
    ds_read_b64_tr_b16 v[78:79], v15 offset:2304
    v_mfma_f32_16x16x32_bf16 v[140:143], v[64:67], v[60:63], v[140:143]
    s_waitcnt lgkmcnt(4)
    v_mfma_f32_16x16x32_bf16 v[144:147], v[68:71], v[48:51], v[144:147]
    ds_read_b64_tr_b16 v[64:65], v16 offset:2048
    v_mfma_f32_16x16x32_bf16 v[148:151], v[68:71], v[52:55], v[148:151]
    v_mfma_f32_16x16x32_bf16 v[152:155], v[68:71], v[56:59], v[152:155]
    ds_read_b64_tr_b16 v[66:67], v16 offset:2304
    v_mfma_f32_16x16x32_bf16 v[156:159], v[68:71], v[60:63], v[156:159]
    s_waitcnt lgkmcnt(4)
    v_mfma_f32_16x16x32_bf16 v[160:163], v[72:75], v[48:51], v[160:163]
    ds_read_b64_tr_b16 v[68:69], v17 offset:2048
    v_mfma_f32_16x16x32_bf16 v[164:167], v[72:75], v[52:55], v[164:167]
    v_mfma_f32_16x16x32_bf16 v[168:171], v[72:75], v[56:59], v[168:171]
    ds_read_b64_tr_b16 v[70:71], v17 offset:2304
    v_mfma_f32_16x16x32_bf16 v[172:175], v[72:75], v[60:63], v[172:175]
    s_waitcnt lgkmcnt(4)
    v_mfma_f32_16x16x32_bf16 v[176:179], v[76:79], v[48:51], v[176:179]
    ds_read_b64_tr_b16 v[72:73], v18 offset:2048
    v_mfma_f32_16x16x32_bf16 v[180:183], v[76:79], v[52:55], v[180:183]
    v_mfma_f32_16x16x32_bf16 v[184:187], v[76:79], v[56:59], v[184:187]
    ds_read_b64_tr_b16 v[74:75], v18 offset:2304
    v_mfma_f32_16x16x32_bf16 v[188:191], v[76:79], v[60:63], v[188:191]
    s_waitcnt lgkmcnt(4)
    v_mfma_f32_16x16x32_bf16 v[192:195], v[64:67], v[48:51], v[192:195]
    ds_read_b64_tr_b16 v[76:77], v19 offset:2048
    v_mfma_f32_16x16x32_bf16 v[196:199], v[64:67], v[52:55], v[196:199]
    v_mfma_f32_16x16x32_bf16 v[200:203], v[64:67], v[56:59], v[200:203]
    ds_read_b64_tr_b16 v[78:79], v19 offset:2304
    v_mfma_f32_16x16x32_bf16 v[204:207], v[64:67], v[60:63], v[204:207]
    s_waitcnt vmcnt(1) lgkmcnt(0)
    s_barrier
    s_sub_u32 s53, s53, 1
    s_cmp_lg_u32 s53, 0
    s_cbranch_scc1 L_g1_loop
    v_mfma_f32_16x16x32_bf16 v[208:211], v[68:71], v[48:51], v[208:211]
    ds_read_b64_tr_b16 v[64:65], v10 offset:40960
    v_mfma_f32_16x16x32_bf16 v[212:215], v[68:71], v[52:55], v[212:215]
    ds_read_b64_tr_b16 v[66:67], v10 offset:41216
    v_mfma_f32_16x16x32_bf16 v[216:219], v[68:71], v[56:59], v[216:219]
    ds_read_b128 v[32:35], v8 offset:32768
    v_mfma_f32_16x16x32_bf16 v[220:223], v[68:71], v[60:63], v[220:223]
    v_mfma_f32_16x16x32_bf16 v[224:227], v[72:75], v[48:51], v[224:227]
    ds_read_b64_tr_b16 v[68:69], v11 offset:40960
    v_mfma_f32_16x16x32_bf16 v[228:231], v[72:75], v[52:55], v[228:231]
    ds_read_b64_tr_b16 v[70:71], v11 offset:41216
    v_mfma_f32_16x16x32_bf16 v[232:235], v[72:75], v[56:59], v[232:235]
    ds_read_b128 v[36:39], v8 offset:34816
    v_mfma_f32_16x16x32_bf16 v[236:239], v[72:75], v[60:63], v[236:239]
    v_mfma_f32_16x16x32_bf16 v[240:243], v[76:79], v[48:51], v[240:243]
    ds_read_b64_tr_b16 v[72:73], v12 offset:40960
    v_mfma_f32_16x16x32_bf16 v[244:247], v[76:79], v[52:55], v[244:247]
    ds_read_b64_tr_b16 v[74:75], v12 offset:41216
    v_mfma_f32_16x16x32_bf16 v[248:251], v[76:79], v[56:59], v[248:251]
    ds_read_b128 v[40:43], v8 offset:36864
    v_mfma_f32_16x16x32_bf16 v[252:255], v[76:79], v[60:63], v[252:255]
    ds_read_b128 v[44:47], v8 offset:38912
    s_waitcnt lgkmcnt(0)
    v_mfma_f32_16x16x32_bf16 v[96:99], v[64:67], v[32:35], v[96:99]
    ds_read_b64_tr_b16 v[76:77], v13 offset:40960
    v_mfma_f32_16x16x32_bf16 v[100:103], v[64:67], v[36:39], v[100:103]
    v_mfma_f32_16x16x32_bf16 v[104:107], v[64:67], v[40:43], v[104:107]
    ds_read_b64_tr_b16 v[78:79], v13 offset:41216
    v_mfma_f32_16x16x32_bf16 v[108:111], v[64:67], v[44:47], v[108:111]
    v_mfma_f32_16x16x32_bf16 v[112:115], v[68:71], v[32:35], v[112:115]
    ds_read_b64_tr_b16 v[64:65], v14 offset:40960
    v_mfma_f32_16x16x32_bf16 v[116:119], v[68:71], v[36:39], v[116:119]
    ds_read_b64_tr_b16 v[66:67], v14 offset:41216
    v_mfma_f32_16x16x32_bf16 v[120:123], v[68:71], v[40:43], v[120:123]
    ds_read_b128 v[48:51], v9 offset:32768
    v_mfma_f32_16x16x32_bf16 v[124:127], v[68:71], v[44:47], v[124:127]
    v_mfma_f32_16x16x32_bf16 v[128:131], v[72:75], v[32:35], v[128:131]
    ds_read_b64_tr_b16 v[68:69], v15 offset:40960
    v_mfma_f32_16x16x32_bf16 v[132:135], v[72:75], v[36:39], v[132:135]
    v_mfma_f32_16x16x32_bf16 v[136:139], v[72:75], v[40:43], v[136:139]
    ds_read_b64_tr_b16 v[70:71], v15 offset:41216
    v_mfma_f32_16x16x32_bf16 v[140:143], v[72:75], v[44:47], v[140:143]
    s_waitcnt lgkmcnt(5)
    v_mfma_f32_16x16x32_bf16 v[144:147], v[76:79], v[32:35], v[144:147]
    ds_read_b64_tr_b16 v[72:73], v16 offset:40960
    v_mfma_f32_16x16x32_bf16 v[148:151], v[76:79], v[36:39], v[148:151]
    ds_read_b64_tr_b16 v[74:75], v16 offset:41216
    v_mfma_f32_16x16x32_bf16 v[152:155], v[76:79], v[40:43], v[152:155]
    ds_read_b128 v[52:55], v9 offset:34816
    v_mfma_f32_16x16x32_bf16 v[156:159], v[76:79], v[44:47], v[156:159]
    s_waitcnt lgkmcnt(6)
    v_mfma_f32_16x16x32_bf16 v[160:163], v[64:67], v[32:35], v[160:163]
    ds_read_b64_tr_b16 v[76:77], v17 offset:40960
    v_mfma_f32_16x16x32_bf16 v[164:167], v[64:67], v[36:39], v[164:167]
    v_mfma_f32_16x16x32_bf16 v[168:171], v[64:67], v[40:43], v[168:171]
    ds_read_b64_tr_b16 v[78:79], v17 offset:41216
    v_mfma_f32_16x16x32_bf16 v[172:175], v[64:67], v[44:47], v[172:175]
    s_waitcnt lgkmcnt(5)
    v_mfma_f32_16x16x32_bf16 v[176:179], v[68:71], v[32:35], v[176:179]
    ds_read_b64_tr_b16 v[64:65], v18 offset:40960
    v_mfma_f32_16x16x32_bf16 v[180:183], v[68:71], v[36:39], v[180:183]
    ds_read_b64_tr_b16 v[66:67], v18 offset:41216
    v_mfma_f32_16x16x32_bf16 v[184:187], v[68:71], v[40:43], v[184:187]
    ds_read_b128 v[56:59], v9 offset:36864
    v_mfma_f32_16x16x32_bf16 v[188:191], v[68:71], v[44:47], v[188:191]
    s_waitcnt lgkmcnt(6)
    v_mfma_f32_16x16x32_bf16 v[192:195], v[72:75], v[32:35], v[192:195]
    ds_read_b64_tr_b16 v[68:69], v19 offset:40960
    v_mfma_f32_16x16x32_bf16 v[196:199], v[72:75], v[36:39], v[196:199]
    v_mfma_f32_16x16x32_bf16 v[200:203], v[72:75], v[40:43], v[200:203]
    ds_read_b64_tr_b16 v[70:71], v19 offset:41216
    v_mfma_f32_16x16x32_bf16 v[204:207], v[72:75], v[44:47], v[204:207]
    s_waitcnt lgkmcnt(5)
    v_mfma_f32_16x16x32_bf16 v[208:211], v[76:79], v[32:35], v[208:211]
    ds_read_b64_tr_b16 v[72:73], v10 offset:43008
    v_mfma_f32_16x16x32_bf16 v[212:215], v[76:79], v[36:39], v[212:215]
    ds_read_b64_tr_b16 v[74:75], v10 offset:43264
    v_mfma_f32_16x16x32_bf16 v[216:219], v[76:79], v[40:43], v[216:219]
    ds_read_b128 v[60:63], v9 offset:38912
    v_mfma_f32_16x16x32_bf16 v[220:223], v[76:79], v[44:47], v[220:223]
    s_waitcnt lgkmcnt(6)
    v_mfma_f32_16x16x32_bf16 v[224:227], v[64:67], v[32:35], v[224:227]
    ds_read_b64_tr_b16 v[76:77], v11 offset:43008
    v_mfma_f32_16x16x32_bf16 v[228:231], v[64:67], v[36:39], v[228:231]
    v_mfma_f32_16x16x32_bf16 v[232:235], v[64:67], v[40:43], v[232:235]
    ds_read_b64_tr_b16 v[78:79], v11 offset:43264
    v_mfma_f32_16x16x32_bf16 v[236:239], v[64:67], v[44:47], v[236:239]
    s_waitcnt lgkmcnt(5)
    v_mfma_f32_16x16x32_bf16 v[240:243], v[68:71], v[32:35], v[240:243]
    ds_read_b64_tr_b16 v[64:65], v12 offset:43008
    v_mfma_f32_16x16x32_bf16 v[244:247], v[68:71], v[36:39], v[244:247]
    v_mfma_f32_16x16x32_bf16 v[248:251], v[68:71], v[40:43], v[248:251]
    ds_read_b64_tr_b16 v[66:67], v12 offset:43264
    v_mfma_f32_16x16x32_bf16 v[252:255], v[68:71], v[44:47], v[252:255]
    s_waitcnt lgkmcnt(4)
    v_mfma_f32_16x16x32_bf16 v[96:99], v[72:75], v[48:51], v[96:99]
    ds_read_b64_tr_b16 v[68:69], v13 offset:43008
    v_mfma_f32_16x16x32_bf16 v[100:103], v[72:75], v[52:55], v[100:103]
    v_mfma_f32_16x16x32_bf16 v[104:107], v[72:75], v[56:59], v[104:107]
    ds_read_b64_tr_b16 v[70:71], v13 offset:43264
    v_mfma_f32_16x16x32_bf16 v[108:111], v[72:75], v[60:63], v[108:111]
    s_waitcnt lgkmcnt(4)
    v_mfma_f32_16x16x32_bf16 v[112:115], v[76:79], v[48:51], v[112:115]
    ds_read_b64_tr_b16 v[72:73], v14 offset:43008
    v_mfma_f32_16x16x32_bf16 v[116:119], v[76:79], v[52:55], v[116:119]
    v_mfma_f32_16x16x32_bf16 v[120:123], v[76:79], v[56:59], v[120:123]
    ds_read_b64_tr_b16 v[74:75], v14 offset:43264
    v_mfma_f32_16x16x32_bf16 v[124:127], v[76:79], v[60:63], v[124:127]
    s_waitcnt lgkmcnt(4)
    v_mfma_f32_16x16x32_bf16 v[128:131], v[64:67], v[48:51], v[128:131]
    ds_read_b64_tr_b16 v[76:77], v15 offset:43008
    v_mfma_f32_16x16x32_bf16 v[132:135], v[64:67], v[52:55], v[132:135]
    v_mfma_f32_16x16x32_bf16 v[136:139], v[64:67], v[56:59], v[136:139]
    ds_read_b64_tr_b16 v[78:79], v15 offset:43264
    v_mfma_f32_16x16x32_bf16 v[140:143], v[64:67], v[60:63], v[140:143]
    s_waitcnt lgkmcnt(4)
    v_mfma_f32_16x16x32_bf16 v[144:147], v[68:71], v[48:51], v[144:147]
    ds_read_b64_tr_b16 v[64:65], v16 offset:43008
    v_mfma_f32_16x16x32_bf16 v[148:151], v[68:71], v[52:55], v[148:151]
    v_mfma_f32_16x16x32_bf16 v[152:155], v[68:71], v[56:59], v[152:155]
    ds_read_b64_tr_b16 v[66:67], v16 offset:43264
    v_mfma_f32_16x16x32_bf16 v[156:159], v[68:71], v[60:63], v[156:159]
    s_waitcnt lgkmcnt(4)
    v_mfma_f32_16x16x32_bf16 v[160:163], v[72:75], v[48:51], v[160:163]
    ds_read_b64_tr_b16 v[68:69], v17 offset:43008
    v_mfma_f32_16x16x32_bf16 v[164:167], v[72:75], v[52:55], v[164:167]
    v_mfma_f32_16x16x32_bf16 v[168:171], v[72:75], v[56:59], v[168:171]
    ds_read_b64_tr_b16 v[70:71], v17 offset:43264
    v_mfma_f32_16x16x32_bf16 v[172:175], v[72:75], v[60:63], v[172:175]
    s_waitcnt lgkmcnt(4)
    v_mfma_f32_16x16x32_bf16 v[176:179], v[76:79], v[48:51], v[176:179]
    ds_read_b64_tr_b16 v[72:73], v18 offset:43008
    v_mfma_f32_16x16x32_bf16 v[180:183], v[76:79], v[52:55], v[180:183]
    v_mfma_f32_16x16x32_bf16 v[184:187], v[76:79], v[56:59], v[184:187]
    ds_read_b64_tr_b16 v[74:75], v18 offset:43264
    v_mfma_f32_16x16x32_bf16 v[188:191], v[76:79], v[60:63], v[188:191]
    s_waitcnt lgkmcnt(4)
    v_mfma_f32_16x16x32_bf16 v[192:195], v[64:67], v[48:51], v[192:195]
    ds_read_b64_tr_b16 v[76:77], v19 offset:43008
    v_mfma_f32_16x16x32_bf16 v[196:199], v[64:67], v[52:55], v[196:199]
    v_mfma_f32_16x16x32_bf16 v[200:203], v[64:67], v[56:59], v[200:203]
    ds_read_b64_tr_b16 v[78:79], v19 offset:43264
    v_mfma_f32_16x16x32_bf16 v[204:207], v[64:67], v[60:63], v[204:207]
    s_waitcnt lgkmcnt(0)
    v_mfma_f32_16x16x32_bf16 v[208:211], v[68:71], v[48:51], v[208:211]
    v_mfma_f32_16x16x32_bf16 v[212:215], v[68:71], v[52:55], v[212:215]
    v_mfma_f32_16x16x32_bf16 v[216:219], v[68:71], v[56:59], v[216:219]
    v_mfma_f32_16x16x32_bf16 v[220:223], v[68:71], v[60:63], v[220:223]
    v_mfma_f32_16x16x32_bf16 v[224:227], v[72:75], v[48:51], v[224:227]
    v_mfma_f32_16x16x32_bf16 v[228:231], v[72:75], v[52:55], v[228:231]
    v_mfma_f32_16x16x32_bf16 v[232:235], v[72:75], v[56:59], v[232:235]
    v_mfma_f32_16x16x32_bf16 v[236:239], v[72:75], v[60:63], v[236:239]
    v_mfma_f32_16x16x32_bf16 v[240:243], v[76:79], v[48:51], v[240:243]
    v_mfma_f32_16x16x32_bf16 v[244:247], v[76:79], v[52:55], v[244:247]
    v_mfma_f32_16x16x32_bf16 v[248:251], v[76:79], v[56:59], v[248:251]
    v_mfma_f32_16x16x32_bf16 v[252:255], v[76:79], v[60:63], v[252:255]
    s_lshl_b32 s86, s80, 8
    s_mul_i32 s87, s84, 64
    s_add_u32 s86, s86, s87
    v_add_u32 v5, s86, v3
    v_lshlrev_b32 v6, 6, v5
    v_lshl_add_u32 v6, v4, 4, v6
    v_lshrrev_b32 v7, 1, v4
    s_lshr_b32 s86, s86, 4
    v_add_u32 v7, s86, v7
    s_mov_b32 s87, 147456
    v_mul_lo_u32 v7, v7, s87
    v_and_b32 v5, 1, v4
    v_lshl_add_u32 v5, v5, 4, v3
    v_lshl_add_u32 v7, v5, 4, v7
    s_mov_b32 s88, 0xbfb8aa3b
    s_nop 7
    s_cmp_eq_u32 s60, 0
    s_cbranch_scc1 L_g1_eg0
    s_cmp_eq_u32 s60, 2
    s_cselect_b32 s89, 0x3e8293ee, 1.0
    v_mul_f32 v96, s89, v96
    v_mul_f32 v112, s89, v112
    v_mul_f32 v97, s89, v97
    v_mul_f32 v113, s89, v113
    v_mul_f32 v98, s89, v98
    v_mul_f32 v114, s89, v114
    v_mul_f32 v99, s89, v99
    v_mul_f32 v115, s89, v115
    v_cvt_pk_bf16_f32 v64, v96, v97
    v_cvt_pk_bf16_f32 v65, v98, v99
    v_cvt_pk_bf16_f32 v66, v112, v113
    v_cvt_pk_bf16_f32 v67, v114, v115
    s_nop 1
    v_permlane32_swap_b32 v64, v66
    v_permlane32_swap_b32 v65, v67
    s_nop 1
    v_permlane16_swap_b32 v64, v66
    v_permlane16_swap_b32 v65, v67
    buffer_store_dwordx4 v[64:67], v6, s[4:7], s65 offen offset:0 sc1
    v_mul_f32 v100, s89, v100
    v_mul_f32 v116, s89, v116
    v_mul_f32 v101, s89, v101
    v_mul_f32 v117, s89, v117
    v_mul_f32 v102, s89, v102
    v_mul_f32 v118, s89, v118
    v_mul_f32 v103, s89, v103
    v_mul_f32 v119, s89, v119
    v_cvt_pk_bf16_f32 v68, v100, v101
    v_cvt_pk_bf16_f32 v69, v102, v103
    v_cvt_pk_bf16_f32 v70, v116, v117
    v_cvt_pk_bf16_f32 v71, v118, v119
    s_nop 1
    v_permlane32_swap_b32 v68, v70
    v_permlane32_swap_b32 v69, v71
    s_nop 1
    v_permlane16_swap_b32 v68, v70
    v_permlane16_swap_b32 v69, v71
    buffer_store_dwordx4 v[68:71], v6, s[4:7], s65 offen offset:1024 sc1
    v_mul_f32 v104, s89, v104
    v_mul_f32 v120, s89, v120
    v_mul_f32 v105, s89, v105
    v_mul_f32 v121, s89, v121
    v_mul_f32 v106, s89, v106
    v_mul_f32 v122, s89, v122
    v_mul_f32 v107, s89, v107
    v_mul_f32 v123, s89, v123
    v_cvt_pk_bf16_f32 v72, v104, v105
    v_cvt_pk_bf16_f32 v73, v106, v107
    v_cvt_pk_bf16_f32 v74, v120, v121
    v_cvt_pk_bf16_f32 v75, v122, v123
    s_nop 1
    v_permlane32_swap_b32 v72, v74
    v_permlane32_swap_b32 v73, v75
    s_nop 1
    v_permlane16_swap_b32 v72, v74
    v_permlane16_swap_b32 v73, v75
    buffer_store_dwordx4 v[72:75], v6, s[4:7], s65 offen offset:2048 sc1
    v_mul_f32 v108, s89, v108
    v_mul_f32 v124, s89, v124
    v_mul_f32 v109, s89, v109
    v_mul_f32 v125, s89, v125
    v_mul_f32 v110, s89, v110
    v_mul_f32 v126, s89, v126
    v_mul_f32 v111, s89, v111
    v_mul_f32 v127, s89, v127
    v_cvt_pk_bf16_f32 v76, v108, v109
    v_cvt_pk_bf16_f32 v77, v110, v111
    v_cvt_pk_bf16_f32 v78, v124, v125
    v_cvt_pk_bf16_f32 v79, v126, v127
    s_nop 1
    v_permlane32_swap_b32 v76, v78
    v_permlane32_swap_b32 v77, v79
    s_nop 1
    v_permlane16_swap_b32 v76, v78
    v_permlane16_swap_b32 v77, v79
    buffer_store_dwordx4 v[76:79], v6, s[4:7], s65 offen offset:3072 sc1
    s_branch L_g1_en0
L_g1_eg0:
    v_mul_f32 v48, s88, v96
    v_mul_f32 v49, s88, v97
    v_mul_f32 v50, s88, v98
    v_mul_f32 v51, s88, v99
    v_mul_f32 v52, s88, v100
    v_mul_f32 v53, s88, v101
    v_mul_f32 v54, s88, v102
    v_mul_f32 v55, s88, v103
    v_exp_f32 v48, v48
    v_exp_f32 v49, v49
    v_exp_f32 v50, v50
    v_exp_f32 v51, v51
    v_exp_f32 v52, v52
    v_exp_f32 v53, v53
    v_exp_f32 v54, v54
    v_exp_f32 v55, v55
    v_add_f32 v48, 1.0, v48
    v_add_f32 v49, 1.0, v49
    v_add_f32 v50, 1.0, v50
    v_add_f32 v51, 1.0, v51
    v_add_f32 v52, 1.0, v52
    v_add_f32 v53, 1.0, v53
    v_add_f32 v54, 1.0, v54
    v_add_f32 v55, 1.0, v55
    v_rcp_f32 v48, v48
    v_rcp_f32 v49, v49
    v_rcp_f32 v50, v50
    v_rcp_f32 v51, v51
    v_rcp_f32 v52, v52
    v_rcp_f32 v53, v53
    v_rcp_f32 v54, v54
    v_rcp_f32 v55, v55
    v_mul_f32 v56, v96, v112
    v_mul_f32 v57, v97, v113
    v_mul_f32 v58, v98, v114
    v_mul_f32 v59, v99, v115
    v_mul_f32 v60, v100, v116
    v_mul_f32 v61, v101, v117
    v_mul_f32 v62, v102, v118
    v_mul_f32 v63, v103, v119
    v_mul_f32 v48, v48, v56
    v_mul_f32 v49, v49, v57
    v_mul_f32 v50, v50, v58
    v_mul_f32 v51, v51, v59
    v_mul_f32 v52, v52, v60
    v_mul_f32 v53, v53, v61
    v_mul_f32 v54, v54, v62
    v_mul_f32 v55, v55, v63
    v_cvt_pk_bf16_f32 v64, v48, v49
    v_cvt_pk_bf16_f32 v65, v50, v51
    v_cvt_pk_bf16_f32 v66, v52, v53
    v_cvt_pk_bf16_f32 v67, v54, v55
    s_nop 1
    v_permlane32_swap_b32 v64, v66
    v_permlane32_swap_b32 v65, v67
    s_nop 1
    v_permlane16_swap_b32 v64, v66
    v_permlane16_swap_b32 v65, v67
    buffer_store_dwordx4 v[64:67], v7, s[4:7], s65 offen sc1
    v_mul_f32 v48, s88, v104
    v_mul_f32 v49, s88, v105
    v_mul_f32 v50, s88, v106
    v_mul_f32 v51, s88, v107
    v_mul_f32 v52, s88, v108
    v_mul_f32 v53, s88, v109
    v_mul_f32 v54, s88, v110
    v_mul_f32 v55, s88, v111
    v_exp_f32 v48, v48
    v_exp_f32 v49, v49
    v_exp_f32 v50, v50
    v_exp_f32 v51, v51
    v_exp_f32 v52, v52
    v_exp_f32 v53, v53
    v_exp_f32 v54, v54
    v_exp_f32 v55, v55
    v_add_f32 v48, 1.0, v48
    v_add_f32 v49, 1.0, v49
    v_add_f32 v50, 1.0, v50
    v_add_f32 v51, 1.0, v51
    v_add_f32 v52, 1.0, v52
    v_add_f32 v53, 1.0, v53
    v_add_f32 v54, 1.0, v54
    v_add_f32 v55, 1.0, v55
    v_rcp_f32 v48, v48
    v_rcp_f32 v49, v49
    v_rcp_f32 v50, v50
    v_rcp_f32 v51, v51
    v_rcp_f32 v52, v52
    v_rcp_f32 v53, v53
    v_rcp_f32 v54, v54
    v_rcp_f32 v55, v55
    v_mul_f32 v56, v104, v120
    v_mul_f32 v57, v105, v121
    v_mul_f32 v58, v106, v122
    v_mul_f32 v59, v107, v123
    v_mul_f32 v60, v108, v124
    v_mul_f32 v61, v109, v125
    v_mul_f32 v62, v110, v126
    v_mul_f32 v63, v111, v127
    v_mul_f32 v48, v48, v56
    v_mul_f32 v49, v49, v57
    v_mul_f32 v50, v50, v58
    v_mul_f32 v51, v51, v59
    v_mul_f32 v52, v52, v60
    v_mul_f32 v53, v53, v61
    v_mul_f32 v54, v54, v62
    v_mul_f32 v55, v55, v63
    v_cvt_pk_bf16_f32 v68, v48, v49
    v_cvt_pk_bf16_f32 v69, v50, v51
    v_cvt_pk_bf16_f32 v70, v52, v53
    v_cvt_pk_bf16_f32 v71, v54, v55
    s_nop 1
    v_permlane32_swap_b32 v68, v70
    v_permlane32_swap_b32 v69, v71
    s_nop 1
    v_permlane16_swap_b32 v68, v70
    v_permlane16_swap_b32 v69, v71
    s_add_u32 s65, s65, 294912
    buffer_store_dwordx4 v[68:71], v7, s[4:7], s65 offen sc1
L_g1_en0:
    s_nop 1
    s_cmp_eq_u32 s61, 0
    s_cbranch_scc1 L_g1_eg1
    s_cmp_eq_u32 s61, 2
    s_cselect_b32 s89, 0x3e8293ee, 1.0
    v_mul_f32 v128, s89, v128
    v_mul_f32 v144, s89, v144
    v_mul_f32 v129, s89, v129
    v_mul_f32 v145, s89, v145
    v_mul_f32 v130, s89, v130
    v_mul_f32 v146, s89, v146
    v_mul_f32 v131, s89, v131
    v_mul_f32 v147, s89, v147
    v_cvt_pk_bf16_f32 v64, v128, v129
    v_cvt_pk_bf16_f32 v65, v130, v131
    v_cvt_pk_bf16_f32 v66, v144, v145
    v_cvt_pk_bf16_f32 v67, v146, v147
    s_nop 1
    v_permlane32_swap_b32 v64, v66
    v_permlane32_swap_b32 v65, v67
    s_nop 1
    v_permlane16_swap_b32 v64, v66
    v_permlane16_swap_b32 v65, v67
    buffer_store_dwordx4 v[64:67], v6, s[4:7], s66 offen offset:0 sc1
    v_mul_f32 v132, s89, v132
    v_mul_f32 v148, s89, v148
    v_mul_f32 v133, s89, v133
    v_mul_f32 v149, s89, v149
    v_mul_f32 v134, s89, v134
    v_mul_f32 v150, s89, v150
    v_mul_f32 v135, s89, v135
    v_mul_f32 v151, s89, v151
    v_cvt_pk_bf16_f32 v68, v132, v133
    v_cvt_pk_bf16_f32 v69, v134, v135
    v_cvt_pk_bf16_f32 v70, v148, v149
    v_cvt_pk_bf16_f32 v71, v150, v151
    s_nop 1
    v_permlane32_swap_b32 v68, v70
    v_permlane32_swap_b32 v69, v71
    s_nop 1
    v_permlane16_swap_b32 v68, v70
    v_permlane16_swap_b32 v69, v71
    buffer_store_dwordx4 v[68:71], v6, s[4:7], s66 offen offset:1024 sc1
    v_mul_f32 v136, s89, v136
    v_mul_f32 v152, s89, v152
    v_mul_f32 v137, s89, v137
    v_mul_f32 v153, s89, v153
    v_mul_f32 v138, s89, v138
    v_mul_f32 v154, s89, v154
    v_mul_f32 v139, s89, v139
    v_mul_f32 v155, s89, v155
    v_cvt_pk_bf16_f32 v72, v136, v137
    v_cvt_pk_bf16_f32 v73, v138, v139
    v_cvt_pk_bf16_f32 v74, v152, v153
    v_cvt_pk_bf16_f32 v75, v154, v155
    s_nop 1
    v_permlane32_swap_b32 v72, v74
    v_permlane32_swap_b32 v73, v75
    s_nop 1
    v_permlane16_swap_b32 v72, v74
    v_permlane16_swap_b32 v73, v75
    buffer_store_dwordx4 v[72:75], v6, s[4:7], s66 offen offset:2048 sc1
    v_mul_f32 v140, s89, v140
    v_mul_f32 v156, s89, v156
    v_mul_f32 v141, s89, v141
    v_mul_f32 v157, s89, v157
    v_mul_f32 v142, s89, v142
    v_mul_f32 v158, s89, v158
    v_mul_f32 v143, s89, v143
    v_mul_f32 v159, s89, v159
    v_cvt_pk_bf16_f32 v76, v140, v141
    v_cvt_pk_bf16_f32 v77, v142, v143
    v_cvt_pk_bf16_f32 v78, v156, v157
    v_cvt_pk_bf16_f32 v79, v158, v159
    s_nop 1
    v_permlane32_swap_b32 v76, v78
    v_permlane32_swap_b32 v77, v79
    s_nop 1
    v_permlane16_swap_b32 v76, v78
    v_permlane16_swap_b32 v77, v79
    buffer_store_dwordx4 v[76:79], v6, s[4:7], s66 offen offset:3072 sc1
    s_branch L_g1_en1
L_g1_eg1:
    v_mul_f32 v48, s88, v128
    v_mul_f32 v49, s88, v129
    v_mul_f32 v50, s88, v130
    v_mul_f32 v51, s88, v131
    v_mul_f32 v52, s88, v132
    v_mul_f32 v53, s88, v133
    v_mul_f32 v54, s88, v134
    v_mul_f32 v55, s88, v135
    v_exp_f32 v48, v48
    v_exp_f32 v49, v49
    v_exp_f32 v50, v50
    v_exp_f32 v51, v51
    v_exp_f32 v52, v52
    v_exp_f32 v53, v53
    v_exp_f32 v54, v54
    v_exp_f32 v55, v55
    v_add_f32 v48, 1.0, v48
    v_add_f32 v49, 1.0, v49
    v_add_f32 v50, 1.0, v50
    v_add_f32 v51, 1.0, v51
    v_add_f32 v52, 1.0, v52
    v_add_f32 v53, 1.0, v53
    v_add_f32 v54, 1.0, v54
    v_add_f32 v55, 1.0, v55
    v_rcp_f32 v48, v48
    v_rcp_f32 v49, v49
    v_rcp_f32 v50, v50
    v_rcp_f32 v51, v51
    v_rcp_f32 v52, v52
    v_rcp_f32 v53, v53
    v_rcp_f32 v54, v54
    v_rcp_f32 v55, v55
    v_mul_f32 v56, v128, v144
    v_mul_f32 v57, v129, v145
    v_mul_f32 v58, v130, v146
    v_mul_f32 v59, v131, v147
    v_mul_f32 v60, v132, v148
    v_mul_f32 v61, v133, v149
    v_mul_f32 v62, v134, v150
    v_mul_f32 v63, v135, v151
    v_mul_f32 v48, v48, v56
    v_mul_f32 v49, v49, v57
    v_mul_f32 v50, v50, v58
    v_mul_f32 v51, v51, v59
    v_mul_f32 v52, v52, v60
    v_mul_f32 v53, v53, v61
    v_mul_f32 v54, v54, v62
    v_mul_f32 v55, v55, v63
    v_cvt_pk_bf16_f32 v64, v48, v49
    v_cvt_pk_bf16_f32 v65, v50, v51
    v_cvt_pk_bf16_f32 v66, v52, v53
    v_cvt_pk_bf16_f32 v67, v54, v55
    s_nop 1
    v_permlane32_swap_b32 v64, v66
    v_permlane32_swap_b32 v65, v67
    s_nop 1
    v_permlane16_swap_b32 v64, v66
    v_permlane16_swap_b32 v65, v67
    buffer_store_dwordx4 v[64:67], v7, s[4:7], s66 offen sc1
    v_mul_f32 v48, s88, v136
    v_mul_f32 v49, s88, v137
    v_mul_f32 v50, s88, v138
    v_mul_f32 v51, s88, v139
    v_mul_f32 v52, s88, v140
    v_mul_f32 v53, s88, v141
    v_mul_f32 v54, s88, v142
    v_mul_f32 v55, s88, v143
    v_exp_f32 v48, v48
    v_exp_f32 v49, v49
    v_exp_f32 v50, v50
    v_exp_f32 v51, v51
    v_exp_f32 v52, v52
    v_exp_f32 v53, v53
    v_exp_f32 v54, v54
    v_exp_f32 v55, v55
    v_add_f32 v48, 1.0, v48
    v_add_f32 v49, 1.0, v49
    v_add_f32 v50, 1.0, v50
    v_add_f32 v51, 1.0, v51
    v_add_f32 v52, 1.0, v52
    v_add_f32 v53, 1.0, v53
    v_add_f32 v54, 1.0, v54
    v_add_f32 v55, 1.0, v55
    v_rcp_f32 v48, v48
    v_rcp_f32 v49, v49
    v_rcp_f32 v50, v50
    v_rcp_f32 v51, v51
    v_rcp_f32 v52, v52
    v_rcp_f32 v53, v53
    v_rcp_f32 v54, v54
    v_rcp_f32 v55, v55
    v_mul_f32 v56, v136, v152
    v_mul_f32 v57, v137, v153
    v_mul_f32 v58, v138, v154
    v_mul_f32 v59, v139, v155
    v_mul_f32 v60, v140, v156
    v_mul_f32 v61, v141, v157
    v_mul_f32 v62, v142, v158
    v_mul_f32 v63, v143, v159
    v_mul_f32 v48, v48, v56
    v_mul_f32 v49, v49, v57
    v_mul_f32 v50, v50, v58
    v_mul_f32 v51, v51, v59
    v_mul_f32 v52, v52, v60
    v_mul_f32 v53, v53, v61
    v_mul_f32 v54, v54, v62
    v_mul_f32 v55, v55, v63
    v_cvt_pk_bf16_f32 v68, v48, v49
    v_cvt_pk_bf16_f32 v69, v50, v51
    v_cvt_pk_bf16_f32 v70, v52, v53
    v_cvt_pk_bf16_f32 v71, v54, v55
    s_nop 1
    v_permlane32_swap_b32 v68, v70
    v_permlane32_swap_b32 v69, v71
    s_nop 1
    v_permlane16_swap_b32 v68, v70
    v_permlane16_swap_b32 v69, v71
    s_add_u32 s66, s66, 294912
    buffer_store_dwordx4 v[68:71], v7, s[4:7], s66 offen sc1
L_g1_en1:
    s_nop 1
    s_cmp_eq_u32 s62, 0
    s_cbranch_scc1 L_g1_eg2
    s_cmp_eq_u32 s62, 2
    s_cselect_b32 s89, 0x3e8293ee, 1.0
    v_mul_f32 v160, s89, v160
    v_mul_f32 v176, s89, v176
    v_mul_f32 v161, s89, v161
    v_mul_f32 v177, s89, v177
    v_mul_f32 v162, s89, v162
    v_mul_f32 v178, s89, v178
    v_mul_f32 v163, s89, v163
    v_mul_f32 v179, s89, v179
    v_cvt_pk_bf16_f32 v64, v160, v161
    v_cvt_pk_bf16_f32 v65, v162, v163
    v_cvt_pk_bf16_f32 v66, v176, v177
    v_cvt_pk_bf16_f32 v67, v178, v179
    s_nop 1
    v_permlane32_swap_b32 v64, v66
    v_permlane32_swap_b32 v65, v67
    s_nop 1
    v_permlane16_swap_b32 v64, v66
    v_permlane16_swap_b32 v65, v67
    buffer_store_dwordx4 v[64:67], v6, s[4:7], s67 offen offset:0 sc1
    v_mul_f32 v164, s89, v164
    v_mul_f32 v180, s89, v180
    v_mul_f32 v165, s89, v165
    v_mul_f32 v181, s89, v181
    v_mul_f32 v166, s89, v166
    v_mul_f32 v182, s89, v182
    v_mul_f32 v167, s89, v167
    v_mul_f32 v183, s89, v183
    v_cvt_pk_bf16_f32 v68, v164, v165
    v_cvt_pk_bf16_f32 v69, v166, v167
    v_cvt_pk_bf16_f32 v70, v180, v181
    v_cvt_pk_bf16_f32 v71, v182, v183
    s_nop 1
    v_permlane32_swap_b32 v68, v70
    v_permlane32_swap_b32 v69, v71
    s_nop 1
    v_permlane16_swap_b32 v68, v70
    v_permlane16_swap_b32 v69, v71
    buffer_store_dwordx4 v[68:71], v6, s[4:7], s67 offen offset:1024 sc1
    v_mul_f32 v168, s89, v168
    v_mul_f32 v184, s89, v184
    v_mul_f32 v169, s89, v169
    v_mul_f32 v185, s89, v185
    v_mul_f32 v170, s89, v170
    v_mul_f32 v186, s89, v186
    v_mul_f32 v171, s89, v171
    v_mul_f32 v187, s89, v187
    v_cvt_pk_bf16_f32 v72, v168, v169
    v_cvt_pk_bf16_f32 v73, v170, v171
    v_cvt_pk_bf16_f32 v74, v184, v185
    v_cvt_pk_bf16_f32 v75, v186, v187
    s_nop 1
    v_permlane32_swap_b32 v72, v74
    v_permlane32_swap_b32 v73, v75
    s_nop 1
    v_permlane16_swap_b32 v72, v74
    v_permlane16_swap_b32 v73, v75
    buffer_store_dwordx4 v[72:75], v6, s[4:7], s67 offen offset:2048 sc1
    v_mul_f32 v172, s89, v172
    v_mul_f32 v188, s89, v188
    v_mul_f32 v173, s89, v173
    v_mul_f32 v189, s89, v189
    v_mul_f32 v174, s89, v174
    v_mul_f32 v190, s89, v190
    v_mul_f32 v175, s89, v175
    v_mul_f32 v191, s89, v191
    v_cvt_pk_bf16_f32 v76, v172, v173
    v_cvt_pk_bf16_f32 v77, v174, v175
    v_cvt_pk_bf16_f32 v78, v188, v189
    v_cvt_pk_bf16_f32 v79, v190, v191
    s_nop 1
    v_permlane32_swap_b32 v76, v78
    v_permlane32_swap_b32 v77, v79
    s_nop 1
    v_permlane16_swap_b32 v76, v78
    v_permlane16_swap_b32 v77, v79
    buffer_store_dwordx4 v[76:79], v6, s[4:7], s67 offen offset:3072 sc1
    s_branch L_g1_en2
L_g1_eg2:
    v_mul_f32 v48, s88, v160
    v_mul_f32 v49, s88, v161
    v_mul_f32 v50, s88, v162
    v_mul_f32 v51, s88, v163
    v_mul_f32 v52, s88, v164
    v_mul_f32 v53, s88, v165
    v_mul_f32 v54, s88, v166
    v_mul_f32 v55, s88, v167
    v_exp_f32 v48, v48
    v_exp_f32 v49, v49
    v_exp_f32 v50, v50
    v_exp_f32 v51, v51
    v_exp_f32 v52, v52
    v_exp_f32 v53, v53
    v_exp_f32 v54, v54
    v_exp_f32 v55, v55
    v_add_f32 v48, 1.0, v48
    v_add_f32 v49, 1.0, v49
    v_add_f32 v50, 1.0, v50
    v_add_f32 v51, 1.0, v51
    v_add_f32 v52, 1.0, v52
    v_add_f32 v53, 1.0, v53
    v_add_f32 v54, 1.0, v54
    v_add_f32 v55, 1.0, v55
    v_rcp_f32 v48, v48
    v_rcp_f32 v49, v49
    v_rcp_f32 v50, v50
    v_rcp_f32 v51, v51
    v_rcp_f32 v52, v52
    v_rcp_f32 v53, v53
    v_rcp_f32 v54, v54
    v_rcp_f32 v55, v55
    v_mul_f32 v56, v160, v176
    v_mul_f32 v57, v161, v177
    v_mul_f32 v58, v162, v178
    v_mul_f32 v59, v163, v179
    v_mul_f32 v60, v164, v180
    v_mul_f32 v61, v165, v181
    v_mul_f32 v62, v166, v182
    v_mul_f32 v63, v167, v183
    v_mul_f32 v48, v48, v56
    v_mul_f32 v49, v49, v57
    v_mul_f32 v50, v50, v58
    v_mul_f32 v51, v51, v59
    v_mul_f32 v52, v52, v60
    v_mul_f32 v53, v53, v61
    v_mul_f32 v54, v54, v62
    v_mul_f32 v55, v55, v63
    v_cvt_pk_bf16_f32 v64, v48, v49
    v_cvt_pk_bf16_f32 v65, v50, v51
    v_cvt_pk_bf16_f32 v66, v52, v53
    v_cvt_pk_bf16_f32 v67, v54, v55
    s_nop 1
    v_permlane32_swap_b32 v64, v66
    v_permlane32_swap_b32 v65, v67
    s_nop 1
    v_permlane16_swap_b32 v64, v66
    v_permlane16_swap_b32 v65, v67
    buffer_store_dwordx4 v[64:67], v7, s[4:7], s67 offen sc1
    v_mul_f32 v48, s88, v168
    v_mul_f32 v49, s88, v169
    v_mul_f32 v50, s88, v170
    v_mul_f32 v51, s88, v171
    v_mul_f32 v52, s88, v172
    v_mul_f32 v53, s88, v173
    v_mul_f32 v54, s88, v174
    v_mul_f32 v55, s88, v175
    v_exp_f32 v48, v48
    v_exp_f32 v49, v49
    v_exp_f32 v50, v50
    v_exp_f32 v51, v51
    v_exp_f32 v52, v52
    v_exp_f32 v53, v53
    v_exp_f32 v54, v54
    v_exp_f32 v55, v55
    v_add_f32 v48, 1.0, v48
    v_add_f32 v49, 1.0, v49
    v_add_f32 v50, 1.0, v50
    v_add_f32 v51, 1.0, v51
    v_add_f32 v52, 1.0, v52
    v_add_f32 v53, 1.0, v53
    v_add_f32 v54, 1.0, v54
    v_add_f32 v55, 1.0, v55
    v_rcp_f32 v48, v48
    v_rcp_f32 v49, v49
    v_rcp_f32 v50, v50
    v_rcp_f32 v51, v51
    v_rcp_f32 v52, v52
    v_rcp_f32 v53, v53
    v_rcp_f32 v54, v54
    v_rcp_f32 v55, v55
    v_mul_f32 v56, v168, v184
    v_mul_f32 v57, v169, v185
    v_mul_f32 v58, v170, v186
    v_mul_f32 v59, v171, v187
    v_mul_f32 v60, v172, v188
    v_mul_f32 v61, v173, v189
    v_mul_f32 v62, v174, v190
    v_mul_f32 v63, v175, v191
    v_mul_f32 v48, v48, v56
    v_mul_f32 v49, v49, v57
    v_mul_f32 v50, v50, v58
    v_mul_f32 v51, v51, v59
    v_mul_f32 v52, v52, v60
    v_mul_f32 v53, v53, v61
    v_mul_f32 v54, v54, v62
    v_mul_f32 v55, v55, v63
    v_cvt_pk_bf16_f32 v68, v48, v49
    v_cvt_pk_bf16_f32 v69, v50, v51
    v_cvt_pk_bf16_f32 v70, v52, v53
    v_cvt_pk_bf16_f32 v71, v54, v55
    s_nop 1
    v_permlane32_swap_b32 v68, v70
    v_permlane32_swap_b32 v69, v71
    s_nop 1
    v_permlane16_swap_b32 v68, v70
    v_permlane16_swap_b32 v69, v71
    s_add_u32 s67, s67, 294912
    buffer_store_dwordx4 v[68:71], v7, s[4:7], s67 offen sc1
L_g1_en2:
    s_nop 1
    s_cmp_eq_u32 s63, 0
    s_cbranch_scc1 L_g1_eg3
    s_cmp_eq_u32 s63, 2
    s_cselect_b32 s89, 0x3e8293ee, 1.0
    v_mul_f32 v192, s89, v192
    v_mul_f32 v208, s89, v208
    v_mul_f32 v193, s89, v193
    v_mul_f32 v209, s89, v209
    v_mul_f32 v194, s89, v194
    v_mul_f32 v210, s89, v210
    v_mul_f32 v195, s89, v195
    v_mul_f32 v211, s89, v211
    v_cvt_pk_bf16_f32 v64, v192, v193
    v_cvt_pk_bf16_f32 v65, v194, v195
    v_cvt_pk_bf16_f32 v66, v208, v209
    v_cvt_pk_bf16_f32 v67, v210, v211
    s_nop 1
    v_permlane32_swap_b32 v64, v66
    v_permlane32_swap_b32 v65, v67
    s_nop 1
    v_permlane16_swap_b32 v64, v66
    v_permlane16_swap_b32 v65, v67
    buffer_store_dwordx4 v[64:67], v6, s[4:7], s68 offen offset:0 sc1
    v_mul_f32 v196, s89, v196
    v_mul_f32 v212, s89, v212
    v_mul_f32 v197, s89, v197
    v_mul_f32 v213, s89, v213
    v_mul_f32 v198, s89, v198
    v_mul_f32 v214, s89, v214
    v_mul_f32 v199, s89, v199
    v_mul_f32 v215, s89, v215
    v_cvt_pk_bf16_f32 v68, v196, v197
    v_cvt_pk_bf16_f32 v69, v198, v199
    v_cvt_pk_bf16_f32 v70, v212, v213
    v_cvt_pk_bf16_f32 v71, v214, v215
    s_nop 1
    v_permlane32_swap_b32 v68, v70
    v_permlane32_swap_b32 v69, v71
    s_nop 1
    v_permlane16_swap_b32 v68, v70
    v_permlane16_swap_b32 v69, v71
    buffer_store_dwordx4 v[68:71], v6, s[4:7], s68 offen offset:1024 sc1
    v_mul_f32 v200, s89, v200
    v_mul_f32 v216, s89, v216
    v_mul_f32 v201, s89, v201
    v_mul_f32 v217, s89, v217
    v_mul_f32 v202, s89, v202
    v_mul_f32 v218, s89, v218
    v_mul_f32 v203, s89, v203
    v_mul_f32 v219, s89, v219
    v_cvt_pk_bf16_f32 v72, v200, v201
    v_cvt_pk_bf16_f32 v73, v202, v203
    v_cvt_pk_bf16_f32 v74, v216, v217
    v_cvt_pk_bf16_f32 v75, v218, v219
    s_nop 1
    v_permlane32_swap_b32 v72, v74
    v_permlane32_swap_b32 v73, v75
    s_nop 1
    v_permlane16_swap_b32 v72, v74
    v_permlane16_swap_b32 v73, v75
    buffer_store_dwordx4 v[72:75], v6, s[4:7], s68 offen offset:2048 sc1
    v_mul_f32 v204, s89, v204
    v_mul_f32 v220, s89, v220
    v_mul_f32 v205, s89, v205
    v_mul_f32 v221, s89, v221
    v_mul_f32 v206, s89, v206
    v_mul_f32 v222, s89, v222
    v_mul_f32 v207, s89, v207
    v_mul_f32 v223, s89, v223
    v_cvt_pk_bf16_f32 v76, v204, v205
    v_cvt_pk_bf16_f32 v77, v206, v207
    v_cvt_pk_bf16_f32 v78, v220, v221
    v_cvt_pk_bf16_f32 v79, v222, v223
    s_nop 1
    v_permlane32_swap_b32 v76, v78
    v_permlane32_swap_b32 v77, v79
    s_nop 1
    v_permlane16_swap_b32 v76, v78
    v_permlane16_swap_b32 v77, v79
    buffer_store_dwordx4 v[76:79], v6, s[4:7], s68 offen offset:3072 sc1
    s_branch L_g1_en3
L_g1_eg3:
    v_mul_f32 v48, s88, v192
    v_mul_f32 v49, s88, v193
    v_mul_f32 v50, s88, v194
    v_mul_f32 v51, s88, v195
    v_mul_f32 v52, s88, v196
    v_mul_f32 v53, s88, v197
    v_mul_f32 v54, s88, v198
    v_mul_f32 v55, s88, v199
    v_exp_f32 v48, v48
    v_exp_f32 v49, v49
    v_exp_f32 v50, v50
    v_exp_f32 v51, v51
    v_exp_f32 v52, v52
    v_exp_f32 v53, v53
    v_exp_f32 v54, v54
    v_exp_f32 v55, v55
    v_add_f32 v48, 1.0, v48
    v_add_f32 v49, 1.0, v49
    v_add_f32 v50, 1.0, v50
    v_add_f32 v51, 1.0, v51
    v_add_f32 v52, 1.0, v52
    v_add_f32 v53, 1.0, v53
    v_add_f32 v54, 1.0, v54
    v_add_f32 v55, 1.0, v55
    v_rcp_f32 v48, v48
    v_rcp_f32 v49, v49
    v_rcp_f32 v50, v50
    v_rcp_f32 v51, v51
    v_rcp_f32 v52, v52
    v_rcp_f32 v53, v53
    v_rcp_f32 v54, v54
    v_rcp_f32 v55, v55
    v_mul_f32 v56, v192, v208
    v_mul_f32 v57, v193, v209
    v_mul_f32 v58, v194, v210
    v_mul_f32 v59, v195, v211
    v_mul_f32 v60, v196, v212
    v_mul_f32 v61, v197, v213
    v_mul_f32 v62, v198, v214
    v_mul_f32 v63, v199, v215
    v_mul_f32 v48, v48, v56
    v_mul_f32 v49, v49, v57
    v_mul_f32 v50, v50, v58
    v_mul_f32 v51, v51, v59
    v_mul_f32 v52, v52, v60
    v_mul_f32 v53, v53, v61
    v_mul_f32 v54, v54, v62
    v_mul_f32 v55, v55, v63
    v_cvt_pk_bf16_f32 v64, v48, v49
    v_cvt_pk_bf16_f32 v65, v50, v51
    v_cvt_pk_bf16_f32 v66, v52, v53
    v_cvt_pk_bf16_f32 v67, v54, v55
    s_nop 1
    v_permlane32_swap_b32 v64, v66
    v_permlane32_swap_b32 v65, v67
    s_nop 1
    v_permlane16_swap_b32 v64, v66
    v_permlane16_swap_b32 v65, v67
    buffer_store_dwordx4 v[64:67], v7, s[4:7], s68 offen sc1
    v_mul_f32 v48, s88, v200
    v_mul_f32 v49, s88, v201
    v_mul_f32 v50, s88, v202
    v_mul_f32 v51, s88, v203
    v_mul_f32 v52, s88, v204
    v_mul_f32 v53, s88, v205
    v_mul_f32 v54, s88, v206
    v_mul_f32 v55, s88, v207
    v_exp_f32 v48, v48
    v_exp_f32 v49, v49
    v_exp_f32 v50, v50
    v_exp_f32 v51, v51
    v_exp_f32 v52, v52
    v_exp_f32 v53, v53
    v_exp_f32 v54, v54
    v_exp_f32 v55, v55
    v_add_f32 v48, 1.0, v48
    v_add_f32 v49, 1.0, v49
    v_add_f32 v50, 1.0, v50
    v_add_f32 v51, 1.0, v51
    v_add_f32 v52, 1.0, v52
    v_add_f32 v53, 1.0, v53
    v_add_f32 v54, 1.0, v54
    v_add_f32 v55, 1.0, v55
    v_rcp_f32 v48, v48
    v_rcp_f32 v49, v49
    v_rcp_f32 v50, v50
    v_rcp_f32 v51, v51
    v_rcp_f32 v52, v52
    v_rcp_f32 v53, v53
    v_rcp_f32 v54, v54
    v_rcp_f32 v55, v55
    v_mul_f32 v56, v200, v216
    v_mul_f32 v57, v201, v217
    v_mul_f32 v58, v202, v218
    v_mul_f32 v59, v203, v219
    v_mul_f32 v60, v204, v220
    v_mul_f32 v61, v205, v221
    v_mul_f32 v62, v206, v222
    v_mul_f32 v63, v207, v223
    v_mul_f32 v48, v48, v56
    v_mul_f32 v49, v49, v57
    v_mul_f32 v50, v50, v58
    v_mul_f32 v51, v51, v59
    v_mul_f32 v52, v52, v60
    v_mul_f32 v53, v53, v61
    v_mul_f32 v54, v54, v62
    v_mul_f32 v55, v55, v63
    v_cvt_pk_bf16_f32 v68, v48, v49
    v_cvt_pk_bf16_f32 v69, v50, v51
    v_cvt_pk_bf16_f32 v70, v52, v53
    v_cvt_pk_bf16_f32 v71, v54, v55
    s_nop 1
    v_permlane32_swap_b32 v68, v70
    v_permlane32_swap_b32 v69, v71
    s_nop 1
    v_permlane16_swap_b32 v68, v70
    v_permlane16_swap_b32 v69, v71
    s_add_u32 s68, s68, 294912
    buffer_store_dwordx4 v[68:71], v7, s[4:7], s68 offen sc1
L_g1_en3:
    s_nop 1
    s_cmp_eq_u32 s64, 0
    s_cbranch_scc1 L_g1_eg4
    s_cmp_eq_u32 s64, 2
    s_cselect_b32 s89, 0x3e8293ee, 1.0
    v_mul_f32 v224, s89, v224
    v_mul_f32 v240, s89, v240
    v_mul_f32 v225, s89, v225
    v_mul_f32 v241, s89, v241
    v_mul_f32 v226, s89, v226
    v_mul_f32 v242, s89, v242
    v_mul_f32 v227, s89, v227
    v_mul_f32 v243, s89, v243
    v_cvt_pk_bf16_f32 v64, v224, v225
    v_cvt_pk_bf16_f32 v65, v226, v227
    v_cvt_pk_bf16_f32 v66, v240, v241
    v_cvt_pk_bf16_f32 v67, v242, v243
    s_nop 1
    v_permlane32_swap_b32 v64, v66
    v_permlane32_swap_b32 v65, v67
    s_nop 1
    v_permlane16_swap_b32 v64, v66
    v_permlane16_swap_b32 v65, v67
    buffer_store_dwordx4 v[64:67], v6, s[4:7], s69 offen offset:0 sc1
    v_mul_f32 v228, s89, v228
    v_mul_f32 v244, s89, v244
    v_mul_f32 v229, s89, v229
    v_mul_f32 v245, s89, v245
    v_mul_f32 v230, s89, v230
    v_mul_f32 v246, s89, v246
    v_mul_f32 v231, s89, v231
    v_mul_f32 v247, s89, v247
    v_cvt_pk_bf16_f32 v68, v228, v229
    v_cvt_pk_bf16_f32 v69, v230, v231
    v_cvt_pk_bf16_f32 v70, v244, v245
    v_cvt_pk_bf16_f32 v71, v246, v247
    s_nop 1
    v_permlane32_swap_b32 v68, v70
    v_permlane32_swap_b32 v69, v71
    s_nop 1
    v_permlane16_swap_b32 v68, v70
    v_permlane16_swap_b32 v69, v71
    buffer_store_dwordx4 v[68:71], v6, s[4:7], s69 offen offset:1024 sc1
    v_mul_f32 v232, s89, v232
    v_mul_f32 v248, s89, v248
    v_mul_f32 v233, s89, v233
    v_mul_f32 v249, s89, v249
    v_mul_f32 v234, s89, v234
    v_mul_f32 v250, s89, v250
    v_mul_f32 v235, s89, v235
    v_mul_f32 v251, s89, v251
    v_cvt_pk_bf16_f32 v72, v232, v233
    v_cvt_pk_bf16_f32 v73, v234, v235
    v_cvt_pk_bf16_f32 v74, v248, v249
    v_cvt_pk_bf16_f32 v75, v250, v251
    s_nop 1
    v_permlane32_swap_b32 v72, v74
    v_permlane32_swap_b32 v73, v75
    s_nop 1
    v_permlane16_swap_b32 v72, v74
    v_permlane16_swap_b32 v73, v75
    buffer_store_dwordx4 v[72:75], v6, s[4:7], s69 offen offset:2048 sc1
    v_mul_f32 v236, s89, v236
    v_mul_f32 v252, s89, v252
    v_mul_f32 v237, s89, v237
    v_mul_f32 v253, s89, v253
    v_mul_f32 v238, s89, v238
    v_mul_f32 v254, s89, v254
    v_mul_f32 v239, s89, v239
    v_mul_f32 v255, s89, v255
    v_cvt_pk_bf16_f32 v76, v236, v237
    v_cvt_pk_bf16_f32 v77, v238, v239
    v_cvt_pk_bf16_f32 v78, v252, v253
    v_cvt_pk_bf16_f32 v79, v254, v255
    s_nop 1
    v_permlane32_swap_b32 v76, v78
    v_permlane32_swap_b32 v77, v79
    s_nop 1
    v_permlane16_swap_b32 v76, v78
    v_permlane16_swap_b32 v77, v79
    buffer_store_dwordx4 v[76:79], v6, s[4:7], s69 offen offset:3072 sc1
    s_branch L_g1_en4
L_g1_eg4:
    v_mul_f32 v48, s88, v224
    v_mul_f32 v49, s88, v225
    v_mul_f32 v50, s88, v226
    v_mul_f32 v51, s88, v227
    v_mul_f32 v52, s88, v228
    v_mul_f32 v53, s88, v229
    v_mul_f32 v54, s88, v230
    v_mul_f32 v55, s88, v231
    v_exp_f32 v48, v48
    v_exp_f32 v49, v49
    v_exp_f32 v50, v50
    v_exp_f32 v51, v51
    v_exp_f32 v52, v52
    v_exp_f32 v53, v53
    v_exp_f32 v54, v54
    v_exp_f32 v55, v55
    v_add_f32 v48, 1.0, v48
    v_add_f32 v49, 1.0, v49
    v_add_f32 v50, 1.0, v50
    v_add_f32 v51, 1.0, v51
    v_add_f32 v52, 1.0, v52
    v_add_f32 v53, 1.0, v53
    v_add_f32 v54, 1.0, v54
    v_add_f32 v55, 1.0, v55
    v_rcp_f32 v48, v48
    v_rcp_f32 v49, v49
    v_rcp_f32 v50, v50
    v_rcp_f32 v51, v51
    v_rcp_f32 v52, v52
    v_rcp_f32 v53, v53
    v_rcp_f32 v54, v54
    v_rcp_f32 v55, v55
    v_mul_f32 v56, v224, v240
    v_mul_f32 v57, v225, v241
    v_mul_f32 v58, v226, v242
    v_mul_f32 v59, v227, v243
    v_mul_f32 v60, v228, v244
    v_mul_f32 v61, v229, v245
    v_mul_f32 v62, v230, v246
    v_mul_f32 v63, v231, v247
    v_mul_f32 v48, v48, v56
    v_mul_f32 v49, v49, v57
    v_mul_f32 v50, v50, v58
    v_mul_f32 v51, v51, v59
    v_mul_f32 v52, v52, v60
    v_mul_f32 v53, v53, v61
    v_mul_f32 v54, v54, v62
    v_mul_f32 v55, v55, v63
    v_cvt_pk_bf16_f32 v64, v48, v49
    v_cvt_pk_bf16_f32 v65, v50, v51
    v_cvt_pk_bf16_f32 v66, v52, v53
    v_cvt_pk_bf16_f32 v67, v54, v55
    s_nop 1
    v_permlane32_swap_b32 v64, v66
    v_permlane32_swap_b32 v65, v67
    s_nop 1
    v_permlane16_swap_b32 v64, v66
    v_permlane16_swap_b32 v65, v67
    buffer_store_dwordx4 v[64:67], v7, s[4:7], s69 offen sc1
    v_mul_f32 v48, s88, v232
    v_mul_f32 v49, s88, v233
    v_mul_f32 v50, s88, v234
    v_mul_f32 v51, s88, v235
    v_mul_f32 v52, s88, v236
    v_mul_f32 v53, s88, v237
    v_mul_f32 v54, s88, v238
    v_mul_f32 v55, s88, v239
    v_exp_f32 v48, v48
    v_exp_f32 v49, v49
    v_exp_f32 v50, v50
    v_exp_f32 v51, v51
    v_exp_f32 v52, v52
    v_exp_f32 v53, v53
    v_exp_f32 v54, v54
    v_exp_f32 v55, v55
    v_add_f32 v48, 1.0, v48
    v_add_f32 v49, 1.0, v49
    v_add_f32 v50, 1.0, v50
    v_add_f32 v51, 1.0, v51
    v_add_f32 v52, 1.0, v52
    v_add_f32 v53, 1.0, v53
    v_add_f32 v54, 1.0, v54
    v_add_f32 v55, 1.0, v55
    v_rcp_f32 v48, v48
    v_rcp_f32 v49, v49
    v_rcp_f32 v50, v50
    v_rcp_f32 v51, v51
    v_rcp_f32 v52, v52
    v_rcp_f32 v53, v53
    v_rcp_f32 v54, v54
    v_rcp_f32 v55, v55
    v_mul_f32 v56, v232, v248
    v_mul_f32 v57, v233, v249
    v_mul_f32 v58, v234, v250
    v_mul_f32 v59, v235, v251
    v_mul_f32 v60, v236, v252
    v_mul_f32 v61, v237, v253
    v_mul_f32 v62, v238, v254
    v_mul_f32 v63, v239, v255
    v_mul_f32 v48, v48, v56
    v_mul_f32 v49, v49, v57
    v_mul_f32 v50, v50, v58
    v_mul_f32 v51, v51, v59
    v_mul_f32 v52, v52, v60
    v_mul_f32 v53, v53, v61
    v_mul_f32 v54, v54, v62
    v_mul_f32 v55, v55, v63
    v_cvt_pk_bf16_f32 v68, v48, v49
    v_cvt_pk_bf16_f32 v69, v50, v51
    v_cvt_pk_bf16_f32 v70, v52, v53
    v_cvt_pk_bf16_f32 v71, v54, v55
    s_nop 1
    v_permlane32_swap_b32 v68, v70
    v_permlane32_swap_b32 v69, v71
    s_nop 1
    v_permlane16_swap_b32 v68, v70
    v_permlane16_swap_b32 v69, v71
    s_add_u32 s69, s69, 294912
    buffer_store_dwordx4 v[68:71], v7, s[4:7], s69 offen sc1
L_g1_en4:
    s_nop 1
L_g1_done:
    s_endpgm
.globl mid_kernel
.p2align 8
.type mid_kernel,@function
mid_kernel:
    s_setprio 3
    s_cmp_ge_u32 s2, 768
    s_cbranch_scc1 L_mid_done
    s_load_dwordx2 s[40:41], s[0:1], 72
    v_lshrrev_b32 v1, 6, v0
    v_and_b32 v2, 63, v0
    s_nop 0
    v_readfirstlane_b32 s20, v1
    s_and_b32 s44, s2, 7
    s_lshr_b32 s45, s2, 3
    s_mov_b32 s46, 0x55555556
    s_mul_hi_u32 s46, s45, s46
    s_mul_i32 s47, s46, 3
    s_sub_u32 s47, s45, s47
    s_waitcnt lgkmcnt(0)
    s_cmp_eq_u32 s47, 2
    s_cbranch_scc1 L_mid_dn
    s_mov_b32 s28, s47
    s_lshr_b32 s29, s2, 8
    s_cmp_eq_u32 s29, 1
    s_cselect_b32 s48, 1, 0
    s_cmp_eq_u32 s28, 0
    s_cselect_b32 s48, s48, 0
    s_cmp_eq_u32 s29, 2
    s_cselect_b32 s29, 1, s48
    s_lshl_b32 s46, s46, 1
    s_add_u32 s46, s46, s47
    s_lshl_b32 s42, s44, 2
    s_and_b32 s47, s46, 3
    s_add_u32 s42, s42, s47
    s_lshr_b32 s43, s46, 2
    s_mov_b32 s16, s40
    s_and_b32 s17, s41, 0xffff
    s_mov_b32 s18, 268435456
    s_mov_b32 s19, 0x20000
    s_lshl_b32 s44, s42, 17
    s_add_u32 s45, s44, 8388608
    s_add_u32 s8, s40, s45
    s_addc_u32 s9, s41, 0
    s_and_b32 s9, s9, 0xffff
    s_mov_b32 s10, 131072
    s_mov_b32 s11, 0x20000
    s_add_u32 s45, s44, 12582912
    s_add_u32 s12, s40, s45
    s_addc_u32 s13, s41, 0
    s_and_b32 s13, s13, 0xffff
    s_mov_b32 s14, 131072
    s_mov_b32 s15, 0x20000
    s_lshl_b32 s45, s20, 11
    v_lshlrev_b32 v3, 4, v2
    v_add_u32 v148, s45, v3
    v_and_b32 v3, 3, v2
    v_bfe_u32 v4, v2, 4, 2
    v_xor_b32 v3, v3, v4
    v_lshrrev_b32 v4, 2, v2
    v_lshlrev_b32 v4, 6, v4
    v_lshl_add_u32 v3, v3, 4, v4
    v_add_u32 v147, s45, v3
    s_mov_b32 s26, s45
    s_add_u32 s27, s45, 24576
    s_mov_b32 s24, 0
    s_mov_b32 s25, 0
    s_add_u32 m0, s26, s25
    s_nop 0
    buffer_load_dwordx4 v147, s[8:11], s24 offen lds
    buffer_load_dwordx4 v147, s[8:11], s24 offen offset:1024 lds
    s_add_u32 m0, s27, s25
    s_nop 0
    buffer_load_dwordx4 v148, s[12:15], s24 offen lds
    buffer_load_dwordx4 v148, s[12:15], s24 offen offset:1024 lds
    s_add_u32 s24, s24, 8192
    s_add_u32 s25, s25, 8192
    s_cmp_eq_u32 s25, 24576
    s_cselect_b32 s25, 0, s25
    s_add_u32 m0, s26, s25
    s_nop 0
    buffer_load_dwordx4 v147, s[8:11], s24 offen lds
    buffer_load_dwordx4 v147, s[8:11], s24 offen offset:1024 lds
    s_add_u32 m0, s27, s25
    s_nop 0
    buffer_load_dwordx4 v148, s[12:15], s24 offen lds
    buffer_load_dwordx4 v148, s[12:15], s24 offen offset:1024 lds
    s_add_u32 s24, s24, 8192
    s_add_u32 s25, s25, 8192
    s_cmp_eq_u32 s25, 24576
    s_cselect_b32 s25, 0, s25
    v_and_b32 v3, 31, v2
    v_lshrrev_b32 v4, 5, v2
    s_lshl_b32 s45, s43, 7
    s_lshl_b32 s46, s20, 5
    s_add_u32 s45, s45, s46
    v_add_u32 v5, s45, v3
    v_lshlrev_b32 v6, 6, v5
    v_lshl_add_u32 v6, v4, 4, v6
    s_add_u32 s46, s44, 4194304
    buffer_load_dwordx4 v[8:11], v6, s[16:19], s46 offen
    buffer_load_dwordx4 v[12:15], v6, s[16:19], s46 offen offset:32
    v_lshrrev_b32 v7, 4, v5
    s_mov_b32 s46, 147456
    v_mul_lo_u32 v7, v7, s46
    v_and_b32 v6, 15, v5
    v_lshl_add_u32 v6, v4, 4, v6
    v_lshl_add_u32 v7, v6, 4, v7
    s_lshl_b32 s46, s42, 10
    v_add_u32 v7, s46, v7
    v_bfe_u32 v5, v3, 2, 2
    v_xor_b32 v5, v5, v4
    v_lshlrev_b32 v6, 6, v3
    v_lshl_add_u32 v145, v5, 4, v6
    v_bfe_u32 v5, v2, 2, 2
    v_lshl_add_u32 v5, v4, 2, v5
    v_lshlrev_b32 v5, 6, v5
    v_bfe_u32 v6, v2, 4, 1
    v_lshl_add_u32 v5, v6, 5, v5
    v_and_b32 v6, 3, v2
    v_lshl_add_u32 v5, v6, 3, v5
    v_add_u32 v146, 24576, v5
    v_mov_b32 v141, v145
    v_add_u32 v142, 8192, v145
    v_mov_b32 v143, v146
    s_mov_b32 s23, 8192
    v_mov_b32 v16, 0
    v_mov_b32 v88, 0
    v_mov_b32 v17, 0
    v_mov_b32 v89, 0
    v_mov_b32 v18, 0
    v_mov_b32 v90, 0
    v_mov_b32 v19, 0
    v_mov_b32 v91, 0
    v_mov_b32 v20, 0
    v_mov_b32 v92, 0
    v_mov_b32 v21, 0
    v_mov_b32 v93, 0
    v_mov_b32 v22, 0
    v_mov_b32 v94, 0
    v_mov_b32 v23, 0
    v_mov_b32 v95, 0
    v_mov_b32 v24, 0
    v_mov_b32 v96, 0
    v_mov_b32 v25, 0
    v_mov_b32 v97, 0
    v_mov_b32 v26, 0
    v_mov_b32 v98, 0
    v_mov_b32 v27, 0
    v_mov_b32 v99, 0
    v_mov_b32 v28, 0
    v_mov_b32 v100, 0
    v_mov_b32 v29, 0
    v_mov_b32 v101, 0
    v_mov_b32 v30, 0
    v_mov_b32 v102, 0
    v_mov_b32 v31, 0
    v_mov_b32 v103, 0
    v_mov_b32 v136, 0
    v_mov_b32 v137, 0
    s_mov_b32 s22, 1199570944
    s_mov_b32 s21, 16
    v_xor_b32 v156, 32, v141
    v_xor_b32 v157, 32, v142
    v_mov_b32 v150, 0x3f803f80
    v_and_b32 v151, 31, v2
    v_cmp_eq_u32 vcc, 0, v151
    v_cmp_eq_u32 s[48:49], 17, v151
    s_or_b64 vcc, vcc, s[48:49]
    s_nop 1
    v_cndmask_b32 v72, 0, v150, vcc
    v_mov_b32 v73, v72
    v_mov_b32 v74, v72
    v_mov_b32 v75, v72
    v_mov_b32 v76, 0
    v_mov_b32 v77, 0
    s_waitcnt vmcnt(6)
    s_barrier
    ds_read_b128 v[104:107], v141 offset:0
    ds_read_b128 v[108:111], v156 offset:0
    ds_read_b128 v[112:115], v141 offset:2048
    ds_read_b128 v[116:119], v156 offset:2048
    v_mov_b32 v160, 0
    v_mov_b32 v128, 0
    v_mov_b32 v161, 0
    v_mov_b32 v129, 0
    v_mov_b32 v162, 0
    v_mov_b32 v130, 0
    v_mov_b32 v163, 0
    v_mov_b32 v131, 0
    v_mov_b32 v164, 0
    v_mov_b32 v132, 0
    v_mov_b32 v165, 0
    v_mov_b32 v133, 0
    v_mov_b32 v166, 0
    v_mov_b32 v134, 0
    v_mov_b32 v167, 0
    v_mov_b32 v135, 0
    s_waitcnt vmcnt(0) lgkmcnt(2)
    v_mfma_f32_32x32x16_bf16 v[32:47], v[104:107], v[8:11], v[16:31]
    v_mfma_f32_32x32x16_bf16 v[32:47], v[108:111], v[12:15], v[32:47]
    s_memtime s[30:31]
    s_waitcnt lgkmcnt(0)
    s_nop 15
    s_nop 3
    v_max3_f32 v150, v32, v33, v34
    v_max3_f32 v150, v150, v35, v36
    v_max3_f32 v150, v150, v37, v38
    v_max3_f32 v150, v150, v39, v40
    v_max3_f32 v150, v150, v41, v42
    v_max3_f32 v150, v150, v43, v44
    v_max3_f32 v150, v150, v45, v46
    v_max_f32 v150, v150, v47
    v_mov_b32 v151, v150
    s_nop 1
    v_permlane32_swap_b32 v150, v151
    s_nop 1
    v_max_f32 v150, v150, v151
    v_sub_f32 v16, 0, v150
    v_mov_b32 v17, v16
    v_mov_b32 v18, v16
    v_mov_b32 v19, v16
    v_mov_b32 v20, v16
    v_mov_b32 v21, v16
    v_mov_b32 v22, v16
    v_mov_b32 v23, v16
    v_mov_b32 v24, v16
    v_mov_b32 v25, v16
    v_mov_b32 v26, v16
    v_mov_b32 v27, v16
    v_mov_b32 v28, v16
    v_mov_b32 v29, v16
    v_mov_b32 v30, v16
    v_mov_b32 v31, v16
    v_sub_f32 v32, v32, v150
    v_sub_f32 v33, v33, v150
    v_sub_f32 v34, v34, v150
    v_sub_f32 v35, v35, v150
    v_sub_f32 v36, v36, v150
    v_sub_f32 v37, v37, v150
    v_sub_f32 v38, v38, v150
    v_sub_f32 v39, v39, v150
    v_sub_f32 v40, v40, v150
    v_sub_f32 v41, v41, v150
    v_sub_f32 v42, v42, v150
    v_sub_f32 v43, v43, v150
    v_sub_f32 v44, v44, v150
    v_sub_f32 v45, v45, v150
    v_sub_f32 v46, v46, v150
    v_sub_f32 v47, v47, v150
L_at_loop:
    s_xor_b32 s28, s28, 1
    s_cmp_eq_u32 s28, 0
    s_cbranch_scc1 L_at_p0
    s_setprio 2
    s_branch L_at_p1
L_at_p0:
    s_setprio 1
L_at_p1:
    v_exp_f32 v64, v32
    ds_read_b128 v[104:107], v141 offset:4096
    v_exp_f32 v65, v33
    ds_read_b128 v[108:111], v156 offset:4096
    v_exp_f32 v66, v34
    v_exp_f32 v67, v35
    v_cvt_pk_bf16_f32 v80, v64, v65
    s_waitcnt lgkmcnt(6)
    s_nop 0
    v_add_f32 v150, v76, v77
    v_cmp_nge_f32 vcc, s22, v150
    s_cbranch_vccnz L_at_rare0
L_at_back0:
    v_add_f32 v136, v136, v76
    v_add_f32 v137, v137, v77
    v_mfma_f32_32x32x16_bf16 v[48:63], v[112:115], v[8:11], v[16:31]
    v_exp_f32 v68, v36
    v_exp_f32 v69, v37
    v_cvt_pk_bf16_f32 v81, v66, v67
    s_waitcnt lgkmcnt(2)
    v_mfma_f32_32x32x16_bf16 v[88:103], v[128:131], v[160:163], v[88:103]
    v_exp_f32 v70, v38
    v_exp_f32 v71, v39
    v_cvt_pk_bf16_f32 v82, v68, v69
    v_mfma_f32_32x32x16_bf16 v[48:63], v[116:119], v[12:15], v[48:63]
    v_exp_f32 v64, v40
    ds_read_b64_tr_b16 v[120:121], v143 offset:0
    v_exp_f32 v65, v41
    v_cvt_pk_bf16_f32 v83, v70, v71
    ds_read_b64_tr_b16 v[122:123], v143 offset:512
    v_exp_f32 v66, v42
    v_mfma_f32_16x16x32_bf16 v[76:79], v[72:75], v[80:83], 0
    v_exp_f32 v67, v43
    v_cvt_pk_bf16_f32 v84, v64, v65
    v_mfma_f32_32x32x16_bf16 v[88:103], v[132:135], v[164:167], v[88:103]
    v_exp_f32 v68, v44
    ds_read_b64_tr_b16 v[124:125], v143 offset:1024
    v_exp_f32 v69, v45
    v_cvt_pk_bf16_f32 v85, v66, v67
    ds_read_b64_tr_b16 v[126:127], v143 offset:1536
    v_exp_f32 v70, v46
    v_exp_f32 v71, v47
    v_cvt_pk_bf16_f32 v86, v68, v69
    s_nop 0
    v_cvt_pk_bf16_f32 v87, v70, v71
    s_nop 1
    v_mfma_f32_16x16x32_bf16 v[76:79], v[72:75], v[84:87], v[76:79]
    v_exp_f32 v64, v48
    ds_read_b128 v[112:115], v141 offset:6144
    v_exp_f32 v65, v49
    ds_read_b128 v[116:119], v156 offset:6144
    v_exp_f32 v66, v50
    v_exp_f32 v67, v51
    v_cvt_pk_bf16_f32 v160, v64, v65
    s_waitcnt lgkmcnt(6)
    s_nop 0
    v_add_f32 v150, v76, v77
    v_cmp_nge_f32 vcc, s22, v150
    s_cbranch_vccnz L_at_rare1
L_at_back1:
    v_add_f32 v136, v136, v76
    v_add_f32 v137, v137, v77
    v_mfma_f32_32x32x16_bf16 v[32:47], v[104:107], v[8:11], v[16:31]
    v_exp_f32 v68, v52
    v_exp_f32 v69, v53
    v_cvt_pk_bf16_f32 v161, v66, v67
    s_waitcnt lgkmcnt(2)
    v_mfma_f32_32x32x16_bf16 v[88:103], v[120:123], v[80:83], v[88:103]
    v_exp_f32 v70, v54
    v_exp_f32 v71, v55
    v_cvt_pk_bf16_f32 v162, v68, v69
    v_mfma_f32_32x32x16_bf16 v[32:47], v[108:111], v[12:15], v[32:47]
    v_exp_f32 v64, v56
    ds_read_b64_tr_b16 v[128:129], v143 offset:2048
    v_exp_f32 v65, v57
    v_cvt_pk_bf16_f32 v163, v70, v71
    ds_read_b64_tr_b16 v[130:131], v143 offset:2560
    v_exp_f32 v66, v58
    v_mfma_f32_16x16x32_bf16 v[76:79], v[72:75], v[160:163], 0
    v_exp_f32 v67, v59
    v_cvt_pk_bf16_f32 v164, v64, v65
    v_mfma_f32_32x32x16_bf16 v[88:103], v[124:127], v[84:87], v[88:103]
    v_exp_f32 v68, v60
    ds_read_b64_tr_b16 v[132:133], v143 offset:3072
    v_exp_f32 v69, v61
    v_cvt_pk_bf16_f32 v165, v66, v67
    ds_read_b64_tr_b16 v[134:135], v143 offset:3584
    v_exp_f32 v70, v62
    v_exp_f32 v71, v63
    v_cvt_pk_bf16_f32 v166, v68, v69
    s_nop 0
    v_cvt_pk_bf16_f32 v167, v70, v71
    s_nop 1
    v_mfma_f32_16x16x32_bf16 v[76:79], v[72:75], v[164:167], v[76:79]
    s_waitcnt vmcnt(0) lgkmcnt(0)
    s_barrier
    s_cmp_le_u32 s21, 2
    s_cbranch_scc1 L_at_nodma
    s_add_u32 m0, s26, s25
    s_nop 0
    buffer_load_dwordx4 v147, s[8:11], s24 offen lds
    buffer_load_dwordx4 v147, s[8:11], s24 offen offset:1024 lds
    s_add_u32 m0, s27, s25
    s_nop 0
    buffer_load_dwordx4 v148, s[12:15], s24 offen lds
    buffer_load_dwordx4 v148, s[12:15], s24 offen offset:1024 lds
    s_add_u32 s24, s24, 8192
    s_add_u32 s25, s25, 8192
    s_cmp_eq_u32 s25, 24576
    s_cselect_b32 s25, 0, s25
L_at_nodma:
    v_exp_f32 v64, v32
    ds_read_b128 v[104:107], v142 offset:0
    v_exp_f32 v65, v33
    ds_read_b128 v[108:111], v157 offset:0
    v_exp_f32 v66, v34
    v_exp_f32 v67, v35
    v_cvt_pk_bf16_f32 v80, v64, v65
    s_nop 0
    v_add_f32 v150, v76, v77
    v_cmp_nge_f32 vcc, s22, v150
    s_cbranch_vccnz L_at_rare2
L_at_back2:
    v_add_f32 v136, v136, v76
    v_add_f32 v137, v137, v77
    v_mfma_f32_32x32x16_bf16 v[48:63], v[112:115], v[8:11], v[16:31]
    v_exp_f32 v68, v36
    v_exp_f32 v69, v37
    v_cvt_pk_bf16_f32 v81, v66, v67
    v_mfma_f32_32x32x16_bf16 v[88:103], v[128:131], v[160:163], v[88:103]
    v_exp_f32 v70, v38
    v_exp_f32 v71, v39
    v_cvt_pk_bf16_f32 v82, v68, v69
    v_mfma_f32_32x32x16_bf16 v[48:63], v[116:119], v[12:15], v[48:63]
    v_exp_f32 v64, v40
    ds_read_b64_tr_b16 v[120:121], v143 offset:4096
    v_exp_f32 v65, v41
    v_cvt_pk_bf16_f32 v83, v70, v71
    ds_read_b64_tr_b16 v[122:123], v143 offset:4608
    v_exp_f32 v66, v42
    v_mfma_f32_16x16x32_bf16 v[76:79], v[72:75], v[80:83], 0
    v_exp_f32 v67, v43
    v_cvt_pk_bf16_f32 v84, v64, v65
    v_mfma_f32_32x32x16_bf16 v[88:103], v[132:135], v[164:167], v[88:103]
    v_exp_f32 v68, v44
    ds_read_b64_tr_b16 v[124:125], v143 offset:5120
    v_exp_f32 v69, v45
    v_cvt_pk_bf16_f32 v85, v66, v67
    ds_read_b64_tr_b16 v[126:127], v143 offset:5632
    v_exp_f32 v70, v46
    v_exp_f32 v71, v47
    v_cvt_pk_bf16_f32 v86, v68, v69
    s_nop 0
    v_cvt_pk_bf16_f32 v87, v70, v71
    s_nop 1
    v_mfma_f32_16x16x32_bf16 v[76:79], v[72:75], v[84:87], v[76:79]
    v_exp_f32 v64, v48
    ds_read_b128 v[112:115], v142 offset:2048
    v_exp_f32 v65, v49
    ds_read_b128 v[116:119], v157 offset:2048
    v_exp_f32 v66, v50
    v_exp_f32 v67, v51
    v_cvt_pk_bf16_f32 v160, v64, v65
    s_waitcnt lgkmcnt(6)
    s_nop 0
    v_add_f32 v150, v76, v77
    v_cmp_nge_f32 vcc, s22, v150
    s_cbranch_vccnz L_at_rare3
L_at_back3:
    v_add_f32 v136, v136, v76
    v_add_f32 v137, v137, v77
    v_mfma_f32_32x32x16_bf16 v[32:47], v[104:107], v[8:11], v[16:31]
    v_exp_f32 v68, v52
    v_exp_f32 v69, v53
    v_cvt_pk_bf16_f32 v161, v66, v67
    s_waitcnt lgkmcnt(2)
    v_mfma_f32_32x32x16_bf16 v[88:103], v[120:123], v[80:83], v[88:103]
    v_exp_f32 v70, v54
    v_exp_f32 v71, v55
    v_cvt_pk_bf16_f32 v162, v68, v69
    v_mfma_f32_32x32x16_bf16 v[32:47], v[108:111], v[12:15], v[32:47]
    v_exp_f32 v64, v56
    ds_read_b64_tr_b16 v[128:129], v143 offset:6144
    v_exp_f32 v65, v57
    v_cvt_pk_bf16_f32 v163, v70, v71
    ds_read_b64_tr_b16 v[130:131], v143 offset:6656
    v_exp_f32 v66, v58
    v_mfma_f32_16x16x32_bf16 v[76:79], v[72:75], v[160:163], 0
    v_exp_f32 v67, v59
    v_cvt_pk_bf16_f32 v164, v64, v65
    v_mfma_f32_32x32x16_bf16 v[88:103], v[124:127], v[84:87], v[88:103]
    v_exp_f32 v68, v60
    ds_read_b64_tr_b16 v[132:133], v143 offset:7168
    v_exp_f32 v69, v61
    v_cvt_pk_bf16_f32 v165, v66, v67
    ds_read_b64_tr_b16 v[134:135], v143 offset:7680
    v_exp_f32 v70, v62
    v_exp_f32 v71, v63
    v_cvt_pk_bf16_f32 v166, v68, v69
    s_nop 0
    v_cvt_pk_bf16_f32 v167, v70, v71
    s_nop 1
    v_mfma_f32_16x16x32_bf16 v[76:79], v[72:75], v[164:167], v[76:79]
    v_mov_b32 v141, v142
    v_mov_b32 v156, v157
    v_add_u32 v143, s23, v146
    s_add_u32 s23, s23, 8192
    s_cmp_eq_u32 s23, 24576
    s_cselect_b32 s23, 0, s23
    v_add_u32 v142, s23, v145
    v_xor_b32 v157, 32, v142
    s_sub_u32 s21, s21, 1
    s_cmp_lg_u32 s21, 0
    s_cbranch_scc1 L_at_loop
    s_branch L_at_epi
L_at_rare0:
    v_max3_f32 v150, v48, v49, v50
    v_max3_f32 v150, v150, v51, v52
    v_max3_f32 v150, v150, v53, v54
    v_max3_f32 v150, v150, v55, v56
    v_max3_f32 v150, v150, v57, v58
    v_max3_f32 v150, v150, v59, v60
    v_max3_f32 v150, v150, v61, v62
    v_max_f32 v150, v150, v63
    v_mov_b32 v151, v150
    s_nop 1
    v_permlane32_swap_b32 v150, v151
    s_nop 1
    v_max_f32 v150, v150, v151
    v_max_f32 v150, 0, v150
    v_exp_f32 v151, -v150
    v_sub_f32 v16, v16, v150
    v_mov_b32 v17, v16
    v_mov_b32 v18, v16
    v_mov_b32 v19, v16
    v_mov_b32 v20, v16
    v_mov_b32 v21, v16
    v_mov_b32 v22, v16
    v_mov_b32 v23, v16
    v_mov_b32 v24, v16
    v_mov_b32 v25, v16
    v_mov_b32 v26, v16
    v_mov_b32 v27, v16
    v_mov_b32 v28, v16
    v_mov_b32 v29, v16
    v_mov_b32 v30, v16
    v_mov_b32 v31, v16
    v_mov_b32 v152, v151
    v_mov_b32 v153, v151
    s_nop 1
    v_permlane16_swap_b32 v152, v153
    s_nop 7
    v_mul_f32 v136, v136, v151
    v_mul_f32 v137, v137, v153
    v_mul_f32 v88, v88, v151
    v_mul_f32 v89, v89, v151
    v_mul_f32 v90, v90, v151
    v_mul_f32 v91, v91, v151
    v_mul_f32 v92, v92, v151
    v_mul_f32 v93, v93, v151
    v_mul_f32 v94, v94, v151
    v_mul_f32 v95, v95, v151
    v_mul_f32 v96, v96, v151
    v_mul_f32 v97, v97, v151
    v_mul_f32 v98, v98, v151
    v_mul_f32 v99, v99, v151
    v_mul_f32 v100, v100, v151
    v_mul_f32 v101, v101, v151
    v_mul_f32 v102, v102, v151
    v_mul_f32 v103, v103, v151
    v_sub_f32 v48, v48, v150
    v_sub_f32 v32, v32, v150
    v_sub_f32 v49, v49, v150
    v_sub_f32 v33, v33, v150
    v_sub_f32 v50, v50, v150
    v_sub_f32 v34, v34, v150
    v_sub_f32 v51, v51, v150
    v_sub_f32 v35, v35, v150
    v_sub_f32 v52, v52, v150
    v_sub_f32 v36, v36, v150
    v_sub_f32 v53, v53, v150
    v_sub_f32 v37, v37, v150
    v_sub_f32 v54, v54, v150
    v_sub_f32 v38, v38, v150
    v_sub_f32 v55, v55, v150
    v_sub_f32 v39, v39, v150
    v_sub_f32 v56, v56, v150
    v_sub_f32 v40, v40, v150
    v_sub_f32 v57, v57, v150
    v_sub_f32 v41, v41, v150
    v_sub_f32 v58, v58, v150
    v_sub_f32 v42, v42, v150
    v_sub_f32 v59, v59, v150
    v_sub_f32 v43, v43, v150
    v_sub_f32 v60, v60, v150
    v_sub_f32 v44, v44, v150
    v_sub_f32 v61, v61, v150
    v_sub_f32 v45, v45, v150
    v_sub_f32 v62, v62, v150
    v_sub_f32 v46, v46, v150
    v_sub_f32 v63, v63, v150
    v_sub_f32 v47, v47, v150
    v_exp_f32 v64, v48
    v_exp_f32 v65, v49
    v_exp_f32 v66, v50
    v_exp_f32 v67, v51
    v_cvt_pk_bf16_f32 v160, v64, v65
    v_exp_f32 v68, v52
    v_exp_f32 v69, v53
    v_cvt_pk_bf16_f32 v161, v66, v67
    v_exp_f32 v70, v54
    v_exp_f32 v71, v55
    v_cvt_pk_bf16_f32 v162, v68, v69
    v_exp_f32 v64, v56
    v_exp_f32 v65, v57
    v_cvt_pk_bf16_f32 v163, v70, v71
    v_exp_f32 v66, v58
    v_exp_f32 v67, v59
    v_cvt_pk_bf16_f32 v164, v64, v65
    v_exp_f32 v68, v60
    v_exp_f32 v69, v61
    v_cvt_pk_bf16_f32 v165, v66, v67
    v_exp_f32 v70, v62
    v_exp_f32 v71, v63
    v_cvt_pk_bf16_f32 v166, v68, v69
    s_nop 0
    v_cvt_pk_bf16_f32 v167, v70, v71
    s_nop 1
    v_mfma_f32_16x16x32_bf16 v[76:79], v[72:75], v[160:163], 0
    v_mfma_f32_16x16x32_bf16 v[76:79], v[72:75], v[164:167], v[76:79]
    v_exp_f32 v64, v32
    v_exp_f32 v65, v33
    v_exp_f32 v66, v34
    v_exp_f32 v67, v35
    v_cvt_pk_bf16_f32 v80, v64, v65
    s_nop 7
    s_nop 3
    s_branch L_at_back0
L_at_rare1:
    v_max3_f32 v150, v32, v33, v34
    v_max3_f32 v150, v150, v35, v36
    v_max3_f32 v150, v150, v37, v38
    v_max3_f32 v150, v150, v39, v40
    v_max3_f32 v150, v150, v41, v42
    v_max3_f32 v150, v150, v43, v44
    v_max3_f32 v150, v150, v45, v46
    v_max_f32 v150, v150, v47
    v_mov_b32 v151, v150
    s_nop 1
    v_permlane32_swap_b32 v150, v151
    s_nop 1
    v_max_f32 v150, v150, v151
    v_max_f32 v150, 0, v150
    v_exp_f32 v151, -v150
    v_sub_f32 v16, v16, v150
    v_mov_b32 v17, v16
    v_mov_b32 v18, v16
    v_mov_b32 v19, v16
    v_mov_b32 v20, v16
    v_mov_b32 v21, v16
    v_mov_b32 v22, v16
    v_mov_b32 v23, v16
    v_mov_b32 v24, v16
    v_mov_b32 v25, v16
    v_mov_b32 v26, v16
    v_mov_b32 v27, v16
    v_mov_b32 v28, v16
    v_mov_b32 v29, v16
    v_mov_b32 v30, v16
    v_mov_b32 v31, v16
    v_mov_b32 v152, v151
    v_mov_b32 v153, v151
    s_nop 1
    v_permlane16_swap_b32 v152, v153
    s_nop 7
    v_mul_f32 v136, v136, v151
    v_mul_f32 v137, v137, v153
    v_mul_f32 v88, v88, v151
    v_mul_f32 v89, v89, v151
    v_mul_f32 v90, v90, v151
    v_mul_f32 v91, v91, v151
    v_mul_f32 v92, v92, v151
    v_mul_f32 v93, v93, v151
    v_mul_f32 v94, v94, v151
    v_mul_f32 v95, v95, v151
    v_mul_f32 v96, v96, v151
    v_mul_f32 v97, v97, v151
    v_mul_f32 v98, v98, v151
    v_mul_f32 v99, v99, v151
    v_mul_f32 v100, v100, v151
    v_mul_f32 v101, v101, v151
    v_mul_f32 v102, v102, v151
    v_mul_f32 v103, v103, v151
    v_sub_f32 v32, v32, v150
    v_sub_f32 v48, v48, v150
    v_sub_f32 v33, v33, v150
    v_sub_f32 v49, v49, v150
    v_sub_f32 v34, v34, v150
    v_sub_f32 v50, v50, v150
    v_sub_f32 v35, v35, v150
    v_sub_f32 v51, v51, v150
    v_sub_f32 v36, v36, v150
    v_sub_f32 v52, v52, v150
    v_sub_f32 v37, v37, v150
    v_sub_f32 v53, v53, v150
    v_sub_f32 v38, v38, v150
    v_sub_f32 v54, v54, v150
    v_sub_f32 v39, v39, v150
    v_sub_f32 v55, v55, v150
    v_sub_f32 v40, v40, v150
    v_sub_f32 v56, v56, v150
    v_sub_f32 v41, v41, v150
    v_sub_f32 v57, v57, v150
    v_sub_f32 v42, v42, v150
    v_sub_f32 v58, v58, v150
    v_sub_f32 v43, v43, v150
    v_sub_f32 v59, v59, v150
    v_sub_f32 v44, v44, v150
    v_sub_f32 v60, v60, v150
    v_sub_f32 v45, v45, v150
    v_sub_f32 v61, v61, v150
    v_sub_f32 v46, v46, v150
    v_sub_f32 v62, v62, v150
    v_sub_f32 v47, v47, v150
    v_sub_f32 v63, v63, v150
    v_exp_f32 v64, v32
    v_exp_f32 v65, v33
    v_exp_f32 v66, v34
    v_exp_f32 v67, v35
    v_cvt_pk_bf16_f32 v80, v64, v65
    v_exp_f32 v68, v36
    v_exp_f32 v69, v37
    v_cvt_pk_bf16_f32 v81, v66, v67
    v_exp_f32 v70, v38
    v_exp_f32 v71, v39
    v_cvt_pk_bf16_f32 v82, v68, v69
    v_exp_f32 v64, v40
    v_exp_f32 v65, v41
    v_cvt_pk_bf16_f32 v83, v70, v71
    v_exp_f32 v66, v42
    v_exp_f32 v67, v43
    v_cvt_pk_bf16_f32 v84, v64, v65
    v_exp_f32 v68, v44
    v_exp_f32 v69, v45
    v_cvt_pk_bf16_f32 v85, v66, v67
    v_exp_f32 v70, v46
    v_exp_f32 v71, v47
    v_cvt_pk_bf16_f32 v86, v68, v69
    s_nop 0
    v_cvt_pk_bf16_f32 v87, v70, v71
    s_nop 1
    v_mfma_f32_16x16x32_bf16 v[76:79], v[72:75], v[80:83], 0
    v_mfma_f32_16x16x32_bf16 v[76:79], v[72:75], v[84:87], v[76:79]
    v_exp_f32 v64, v48
    v_exp_f32 v65, v49
    v_exp_f32 v66, v50
    v_exp_f32 v67, v51
    v_cvt_pk_bf16_f32 v160, v64, v65
    s_nop 7
    s_nop 3
    s_branch L_at_back1
L_at_rare2:
    v_max3_f32 v150, v48, v49, v50
    v_max3_f32 v150, v150, v51, v52
    v_max3_f32 v150, v150, v53, v54
    v_max3_f32 v150, v150, v55, v56
    v_max3_f32 v150, v150, v57, v58
    v_max3_f32 v150, v150, v59, v60
    v_max3_f32 v150, v150, v61, v62
    v_max_f32 v150, v150, v63
    v_mov_b32 v151, v150
    s_nop 1
    v_permlane32_swap_b32 v150, v151
    s_nop 1
    v_max_f32 v150, v150, v151
    v_max_f32 v150, 0, v150
    v_exp_f32 v151, -v150
    v_sub_f32 v16, v16, v150
    v_mov_b32 v17, v16
    v_mov_b32 v18, v16
    v_mov_b32 v19, v16
    v_mov_b32 v20, v16
    v_mov_b32 v21, v16
    v_mov_b32 v22, v16
    v_mov_b32 v23, v16
    v_mov_b32 v24, v16
    v_mov_b32 v25, v16
    v_mov_b32 v26, v16
    v_mov_b32 v27, v16
    v_mov_b32 v28, v16
    v_mov_b32 v29, v16
    v_mov_b32 v30, v16
    v_mov_b32 v31, v16
    v_mov_b32 v152, v151
    v_mov_b32 v153, v151
    s_nop 1
    v_permlane16_swap_b32 v152, v153
    s_nop 7
    v_mul_f32 v136, v136, v151
    v_mul_f32 v137, v137, v153
    v_mul_f32 v88, v88, v151
    v_mul_f32 v89, v89, v151
    v_mul_f32 v90, v90, v151
    v_mul_f32 v91, v91, v151
    v_mul_f32 v92, v92, v151
    v_mul_f32 v93, v93, v151
    v_mul_f32 v94, v94, v151
    v_mul_f32 v95, v95, v151
    v_mul_f32 v96, v96, v151
    v_mul_f32 v97, v97, v151
    v_mul_f32 v98, v98, v151
    v_mul_f32 v99, v99, v151
    v_mul_f32 v100, v100, v151
    v_mul_f32 v101, v101, v151
    v_mul_f32 v102, v102, v151
    v_mul_f32 v103, v103, v151
    v_sub_f32 v48, v48, v150
    v_sub_f32 v32, v32, v150
    v_sub_f32 v49, v49, v150
    v_sub_f32 v33, v33, v150
    v_sub_f32 v50, v50, v150
    v_sub_f32 v34, v34, v150
    v_sub_f32 v51, v51, v150
    v_sub_f32 v35, v35, v150
    v_sub_f32 v52, v52, v150
    v_sub_f32 v36, v36, v150
    v_sub_f32 v53, v53, v150
    v_sub_f32 v37, v37, v150
    v_sub_f32 v54, v54, v150
    v_sub_f32 v38, v38, v150
    v_sub_f32 v55, v55, v150
    v_sub_f32 v39, v39, v150
    v_sub_f32 v56, v56, v150
    v_sub_f32 v40, v40, v150
    v_sub_f32 v57, v57, v150
    v_sub_f32 v41, v41, v150
    v_sub_f32 v58, v58, v150
    v_sub_f32 v42, v42, v150
    v_sub_f32 v59, v59, v150
    v_sub_f32 v43, v43, v150
    v_sub_f32 v60, v60, v150
    v_sub_f32 v44, v44, v150
    v_sub_f32 v61, v61, v150
    v_sub_f32 v45, v45, v150
    v_sub_f32 v62, v62, v150
    v_sub_f32 v46, v46, v150
    v_sub_f32 v63, v63, v150
    v_sub_f32 v47, v47, v150
    v_exp_f32 v64, v48
    v_exp_f32 v65, v49
    v_exp_f32 v66, v50
    v_exp_f32 v67, v51
    v_cvt_pk_bf16_f32 v160, v64, v65
    v_exp_f32 v68, v52
    v_exp_f32 v69, v53
    v_cvt_pk_bf16_f32 v161, v66, v67
    v_exp_f32 v70, v54
    v_exp_f32 v71, v55
    v_cvt_pk_bf16_f32 v162, v68, v69
    v_exp_f32 v64, v56
    v_exp_f32 v65, v57
    v_cvt_pk_bf16_f32 v163, v70, v71
    v_exp_f32 v66, v58
    v_exp_f32 v67, v59
    v_cvt_pk_bf16_f32 v164, v64, v65
    v_exp_f32 v68, v60
    v_exp_f32 v69, v61
    v_cvt_pk_bf16_f32 v165, v66, v67
    v_exp_f32 v70, v62
    v_exp_f32 v71, v63
    v_cvt_pk_bf16_f32 v166, v68, v69
    s_nop 0
    v_cvt_pk_bf16_f32 v167, v70, v71
    s_nop 1
    v_mfma_f32_16x16x32_bf16 v[76:79], v[72:75], v[160:163], 0
    v_mfma_f32_16x16x32_bf16 v[76:79], v[72:75], v[164:167], v[76:79]
    v_exp_f32 v64, v32
    v_exp_f32 v65, v33
    v_exp_f32 v66, v34
    v_exp_f32 v67, v35
    v_cvt_pk_bf16_f32 v80, v64, v65
    s_nop 7
    s_nop 3
    s_branch L_at_back2
L_at_rare3:
    v_max3_f32 v150, v32, v33, v34
    v_max3_f32 v150, v150, v35, v36
    v_max3_f32 v150, v150, v37, v38
    v_max3_f32 v150, v150, v39, v40
    v_max3_f32 v150, v150, v41, v42
    v_max3_f32 v150, v150, v43, v44
    v_max3_f32 v150, v150, v45, v46
    v_max_f32 v150, v150, v47
    v_mov_b32 v151, v150
    s_nop 1
    v_permlane32_swap_b32 v150, v151
    s_nop 1
    v_max_f32 v150, v150, v151
    v_max_f32 v150, 0, v150
    v_exp_f32 v151, -v150
    v_sub_f32 v16, v16, v150
    v_mov_b32 v17, v16
    v_mov_b32 v18, v16
    v_mov_b32 v19, v16
    v_mov_b32 v20, v16
    v_mov_b32 v21, v16
    v_mov_b32 v22, v16
    v_mov_b32 v23, v16
    v_mov_b32 v24, v16
    v_mov_b32 v25, v16
    v_mov_b32 v26, v16
    v_mov_b32 v27, v16
    v_mov_b32 v28, v16
    v_mov_b32 v29, v16
    v_mov_b32 v30, v16
    v_mov_b32 v31, v16
    v_mov_b32 v152, v151
    v_mov_b32 v153, v151
    s_nop 1
    v_permlane16_swap_b32 v152, v153
    s_nop 7
    v_mul_f32 v136, v136, v151
    v_mul_f32 v137, v137, v153
    v_mul_f32 v88, v88, v151
    v_mul_f32 v89, v89, v151
    v_mul_f32 v90, v90, v151
    v_mul_f32 v91, v91, v151
    v_mul_f32 v92, v92, v151
    v_mul_f32 v93, v93, v151
    v_mul_f32 v94, v94, v151
    v_mul_f32 v95, v95, v151
    v_mul_f32 v96, v96, v151
    v_mul_f32 v97, v97, v151
    v_mul_f32 v98, v98, v151
    v_mul_f32 v99, v99, v151
    v_mul_f32 v100, v100, v151
    v_mul_f32 v101, v101, v151
    v_mul_f32 v102, v102, v151
    v_mul_f32 v103, v103, v151
    v_sub_f32 v32, v32, v150
    v_sub_f32 v48, v48, v150
    v_sub_f32 v33, v33, v150
    v_sub_f32 v49, v49, v150
    v_sub_f32 v34, v34, v150
    v_sub_f32 v50, v50, v150
    v_sub_f32 v35, v35, v150
    v_sub_f32 v51, v51, v150
    v_sub_f32 v36, v36, v150
    v_sub_f32 v52, v52, v150
    v_sub_f32 v37, v37, v150
    v_sub_f32 v53, v53, v150
    v_sub_f32 v38, v38, v150
    v_sub_f32 v54, v54, v150
    v_sub_f32 v39, v39, v150
    v_sub_f32 v55, v55, v150
    v_sub_f32 v40, v40, v150
    v_sub_f32 v56, v56, v150
    v_sub_f32 v41, v41, v150
    v_sub_f32 v57, v57, v150
    v_sub_f32 v42, v42, v150
    v_sub_f32 v58, v58, v150
    v_sub_f32 v43, v43, v150
    v_sub_f32 v59, v59, v150
    v_sub_f32 v44, v44, v150
    v_sub_f32 v60, v60, v150
    v_sub_f32 v45, v45, v150
    v_sub_f32 v61, v61, v150
    v_sub_f32 v46, v46, v150
    v_sub_f32 v62, v62, v150
    v_sub_f32 v47, v47, v150
    v_sub_f32 v63, v63, v150
    v_exp_f32 v64, v32
    v_exp_f32 v65, v33
    v_exp_f32 v66, v34
    v_exp_f32 v67, v35
    v_cvt_pk_bf16_f32 v80, v64, v65
    v_exp_f32 v68, v36
    v_exp_f32 v69, v37
    v_cvt_pk_bf16_f32 v81, v66, v67
    v_exp_f32 v70, v38
    v_exp_f32 v71, v39
    v_cvt_pk_bf16_f32 v82, v68, v69
    v_exp_f32 v64, v40
    v_exp_f32 v65, v41
    v_cvt_pk_bf16_f32 v83, v70, v71
    v_exp_f32 v66, v42
    v_exp_f32 v67, v43
    v_cvt_pk_bf16_f32 v84, v64, v65
    v_exp_f32 v68, v44
    v_exp_f32 v69, v45
    v_cvt_pk_bf16_f32 v85, v66, v67
    v_exp_f32 v70, v46
    v_exp_f32 v71, v47
    v_cvt_pk_bf16_f32 v86, v68, v69
    s_nop 0
    v_cvt_pk_bf16_f32 v87, v70, v71
    s_nop 1
    v_mfma_f32_16x16x32_bf16 v[76:79], v[72:75], v[80:83], 0
    v_mfma_f32_16x16x32_bf16 v[76:79], v[72:75], v[84:87], v[76:79]
    v_exp_f32 v64, v48
    v_exp_f32 v65, v49
    v_exp_f32 v66, v50
    v_exp_f32 v67, v51
    v_cvt_pk_bf16_f32 v160, v64, v65
    s_nop 7
    s_nop 3
    s_branch L_at_back3
L_at_raree:
    v_max3_f32 v150, v48, v49, v50
    v_max3_f32 v150, v150, v51, v52
    v_max3_f32 v150, v150, v53, v54
    v_max3_f32 v150, v150, v55, v56
    v_max3_f32 v150, v150, v57, v58
    v_max3_f32 v150, v150, v59, v60
    v_max3_f32 v150, v150, v61, v62
    v_max_f32 v150, v150, v63
    v_mov_b32 v151, v150
    s_nop 1
    v_permlane32_swap_b32 v150, v151
    s_nop 1
    v_max_f32 v150, v150, v151
    v_max_f32 v150, 0, v150
    v_exp_f32 v151, -v150
    v_sub_f32 v16, v16, v150
    v_mov_b32 v17, v16
    v_mov_b32 v18, v16
    v_mov_b32 v19, v16
    v_mov_b32 v20, v16
    v_mov_b32 v21, v16
    v_mov_b32 v22, v16
    v_mov_b32 v23, v16
    v_mov_b32 v24, v16
    v_mov_b32 v25, v16
    v_mov_b32 v26, v16
    v_mov_b32 v27, v16
    v_mov_b32 v28, v16
    v_mov_b32 v29, v16
    v_mov_b32 v30, v16
    v_mov_b32 v31, v16
    v_mov_b32 v152, v151
    v_mov_b32 v153, v151
    s_nop 1
    v_permlane16_swap_b32 v152, v153
    s_nop 7
    v_mul_f32 v136, v136, v151
    v_mul_f32 v137, v137, v153
    v_mul_f32 v88, v88, v151
    v_mul_f32 v89, v89, v151
    v_mul_f32 v90, v90, v151
    v_mul_f32 v91, v91, v151
    v_mul_f32 v92, v92, v151
    v_mul_f32 v93, v93, v151
    v_mul_f32 v94, v94, v151
    v_mul_f32 v95, v95, v151
    v_mul_f32 v96, v96, v151
    v_mul_f32 v97, v97, v151
    v_mul_f32 v98, v98, v151
    v_mul_f32 v99, v99, v151
    v_mul_f32 v100, v100, v151
    v_mul_f32 v101, v101, v151
    v_mul_f32 v102, v102, v151
    v_mul_f32 v103, v103, v151
    v_sub_f32 v48, v48, v150
    v_sub_f32 v49, v49, v150
    v_sub_f32 v50, v50, v150
    v_sub_f32 v51, v51, v150
    v_sub_f32 v52, v52, v150
    v_sub_f32 v53, v53, v150
    v_sub_f32 v54, v54, v150
    v_sub_f32 v55, v55, v150
    v_sub_f32 v56, v56, v150
    v_sub_f32 v57, v57, v150
    v_sub_f32 v58, v58, v150
    v_sub_f32 v59, v59, v150
    v_sub_f32 v60, v60, v150
    v_sub_f32 v61, v61, v150
    v_sub_f32 v62, v62, v150
    v_sub_f32 v63, v63, v150
    v_exp_f32 v64, v48
    v_exp_f32 v65, v49
    v_exp_f32 v66, v50
    v_exp_f32 v67, v51
    v_cvt_pk_bf16_f32 v160, v64, v65
    v_exp_f32 v68, v52
    v_exp_f32 v69, v53
    v_cvt_pk_bf16_f32 v161, v66, v67
    v_exp_f32 v70, v54
    v_exp_f32 v71, v55
    v_cvt_pk_bf16_f32 v162, v68, v69
    v_exp_f32 v64, v56
    v_exp_f32 v65, v57
    v_cvt_pk_bf16_f32 v163, v70, v71
    v_exp_f32 v66, v58
    v_exp_f32 v67, v59
    v_cvt_pk_bf16_f32 v164, v64, v65
    v_exp_f32 v68, v60
    v_exp_f32 v69, v61
    v_cvt_pk_bf16_f32 v165, v66, v67
    v_exp_f32 v70, v62
    v_exp_f32 v71, v63
    v_cvt_pk_bf16_f32 v166, v68, v69
    s_nop 0
    v_cvt_pk_bf16_f32 v167, v70, v71
    s_nop 1
    v_mfma_f32_16x16x32_bf16 v[76:79], v[72:75], v[160:163], 0
    v_mfma_f32_16x16x32_bf16 v[76:79], v[72:75], v[164:167], v[76:79]
    s_nop 7
    s_nop 3
    s_branch L_at_backe
L_at_epi:
    s_waitcnt lgkmcnt(0)
    s_nop 7
    s_nop 0
    v_add_f32 v150, v76, v77
    v_cmp_nge_f32 vcc, s22, v150
    s_cbranch_vccnz L_at_raree
L_at_backe:
    v_add_f32 v136, v136, v76
    v_add_f32 v137, v137, v77
    v_mfma_f32_32x32x16_bf16 v[88:103], v[128:131], v[160:163], v[88:103]
    v_mfma_f32_32x32x16_bf16 v[88:103], v[132:135], v[164:167], v[88:103]
    s_nop 1
    v_permlane16_swap_b32 v136, v137
    s_nop 1
    v_mov_b32 v150, v136
    s_nop 1
    v_permlane32_swap_b32 v150, v136
    s_nop 1
    v_rcp_f32 v150, v150
    s_nop 7
    s_nop 7
    v_mul_f32 v88, v88, v150
    v_mul_f32 v89, v89, v150
    v_mul_f32 v90, v90, v150
    v_mul_f32 v91, v91, v150
    v_mul_f32 v92, v92, v150
    v_mul_f32 v93, v93, v150
    v_mul_f32 v94, v94, v150
    v_mul_f32 v95, v95, v150
    v_mul_f32 v96, v96, v150
    v_mul_f32 v97, v97, v150
    v_mul_f32 v98, v98, v150
    v_mul_f32 v99, v99, v150
    v_mul_f32 v100, v100, v150
    v_mul_f32 v101, v101, v150
    v_mul_f32 v102, v102, v150
    v_mul_f32 v103, v103, v150
    v_cvt_pk_bf16_f32 v80, v88, v89
    v_cvt_pk_bf16_f32 v81, v90, v91
    v_cvt_pk_bf16_f32 v82, v92, v93
    v_cvt_pk_bf16_f32 v83, v94, v95
    v_cvt_pk_bf16_f32 v84, v96, v97
    v_cvt_pk_bf16_f32 v85, v98, v99
    v_cvt_pk_bf16_f32 v86, v100, v101
    v_cvt_pk_bf16_f32 v87, v102, v103
    s_nop 1
    v_permlane32_swap_b32 v80, v82
    v_permlane32_swap_b32 v81, v83
    v_permlane32_swap_b32 v84, v86
    v_permlane32_swap_b32 v85, v87
    s_mov_b32 s46, 41943040
    buffer_store_dwordx4 v[80:83], v7, s[16:19], s46 offen offset:0 sc1
    buffer_store_dwordx4 v[84:87], v7, s[16:19], s46 offen offset:512 sc1
    s_lshl_b32 s50, s43, 7
    s_lshl_b32 s51, s42, 2
    s_add_u32 s50, s50, s51
    s_add_u32 s50, s50, 62914560
    v_mov_b32 v150, s50
    v_mov_b32 v151, 1
    s_waitcnt vmcnt(0) lgkmcnt(0)
    s_barrier
    s_cmp_lg_u32 s20, 0
    s_cbranch_scc1 L_at_nosig
    s_mov_b64 exec, 1
    global_store_dword v150, v151, s[40:41] sc1
    s_mov_b64 exec, -1
L_at_nosig:
    s_endpgm
L_mid_dn:
    s_lshr_b32 s42, s44, 1
    s_lshl_b32 s42, s42, 2
    s_and_b32 s47, s46, 3
    s_add_u32 s42, s42, s47
    s_and_b32 s43, s44, 1
    s_lshl_b32 s43, s43, 3
    s_lshr_b32 s47, s46, 2
    s_add_u32 s43, s43, s47
    v_mov_b32 v72, v2
    s_load_dwordx2 s[44:45], s[0:1], 48
    s_load_dwordx2 s[46:47], s[0:1], 0
    s_load_dwordx2 s[52:53], s[0:1], 16
    s_load_dwordx2 s[54:55], s[0:1], 56
    s_load_dwordx2 s[32:33], s[0:1], 64
    s_and_b32 s48, s20, 1
    s_lshr_b32 s49, s20, 1
    s_lshl_b32 s50, s42, 3
    s_lshl_b32 s51, s48, 2
    s_add_u32 s50, s50, s51
    s_mul_i32 s51, s50, 147456
    s_add_u32 s51, s51, 41943040
    s_add_u32 s8, s40, s51
    s_addc_u32 s9, s41, 0
    s_and_b32 s9, s9, 0xffff
    s_mov_b32 s10, 589824
    s_mov_b32 s11, 0x20000
    s_lshl_b32 s22, s49, 10
    s_add_u32 s22, s22, 32768
    v_and_b32 v73, 31, v72
    v_lshrrev_b32 v74, 5, v72
    v_lshrrev_b32 v75, 4, v73
    s_mov_b32 s51, 147456
    v_mul_lo_u32 v75, v75, s51
    v_and_b32 v76, 15, v73
    v_lshl_add_u32 v76, v74, 4, v76
    v_lshl_add_u32 v0, v76, 4, v75
    v_add_u32 v1, 294912, v0
    s_waitcnt lgkmcnt(0)
    s_lshl_b32 s51, s43, 7
    s_add_u32 s12, s44, s51
    s_addc_u32 s13, s45, 0
    s_and_b32 s13, s13, 0xffff
    s_sub_u32 s14, 7340032, s51
    s_mov_b32 s15, 0x20000
    s_add_u32 s30, s52, s51
    s_addc_u32 s31, s53, 0
    s_and_b32 s31, s31, 0xffff
    s_mov_b32 s23, 0
    s_lshl_b32 s28, s20, 11
    s_mov_b32 s16, s46
    s_and_b32 s17, s47, 0xffff
    s_mov_b32 s18, 0x400000
    s_mov_b32 s19, 0x20000
    s_mov_b32 s24, s54
    s_and_b32 s25, s55, 0xffff
    s_mov_b32 s26, 0x400000
    s_mov_b32 s27, 0x20000
    v_lshrrev_b32 v75, 3, v72
    v_bfe_u32 v76, v72, 4, 1
    v_lshlrev_b32 v76, 2, v76
    v_and_b32 v77, 7, v72
    v_xor_b32 v76, v76, v77
    s_lshl_b32 s51, s20, 4
    v_add_u32 v75, s51, v75
    v_lshlrev_b32 v75, 11, v75
    v_lshl_add_u32 v2, v76, 4, v75
    v_add_u32 v3, 16384, v2
    v_bfe_u32 v75, v72, 2, 2
    v_lshl_add_u32 v75, v74, 3, v75
    s_lshl_b32 s51, s49, 5
    v_add_u32 v75, s51, v75
    v_lshlrev_b32 v75, 7, v75
    v_bfe_u32 v76, v72, 4, 1
    v_lshl_add_u32 v75, v76, 5, v75
    v_and_b32 v76, 3, v72
    v_lshl_add_u32 v75, v76, 3, v75
    v_bfe_u32 v76, v72, 3, 1
    v_lshl_add_u32 v4, v76, 6, v75
    v_xor_b32 v5, 64, v4
    v_mbcnt_lo_u32_b32 v152, -1, 0
    v_mbcnt_hi_u32_b32 v152, -1, v152
    v_and_b32 v153, 31, v152
    v_lshrrev_b32 v154, 5, v152
    s_lshl_b32 s51, s42, 7
    s_lshl_b32 s52, s48, 6
    s_add_u32 s51, s51, s52
    v_add_u32 v155, s51, v153
    v_lshlrev_b32 v155, 11, v155
    s_lshl_b32 s51, s43, 7
    s_lshl_b32 s52, s49, 6
    s_add_u32 s51, s51, s52
    v_add_u32 v155, s51, v155
    v_lshl_add_u32 v155, v154, 3, v155
    s_mov_b32 s51, 65536
    buffer_load_dwordx2 v[136:137], v155, s[16:19], 0 offen offset:0
    buffer_load_dwordx2 v[138:139], v155, s[16:19], 0 offen offset:16
    buffer_load_dwordx2 v[140:141], v155, s[16:19], 0 offen offset:32
    buffer_load_dwordx2 v[142:143], v155, s[16:19], 0 offen offset:48
    buffer_load_dwordx2 v[144:145], v155, s[16:19], s51 offen offset:0
    buffer_load_dwordx2 v[146:147], v155, s[16:19], s51 offen offset:16
    buffer_load_dwordx2 v[148:149], v155, s[16:19], s51 offen offset:32
    buffer_load_dwordx2 v[150:151], v155, s[16:19], s51 offen offset:48
    s_waitcnt vmcnt(0)
    s_cmp_eq_u32 s49, 0
    s_cbranch_scc1 L_dn_x0
    v_lshlrev_b32 v40, 16, v136
    v_and_b32 v41, 0xffff0000, v136
    v_lshlrev_b32 v42, 16, v137
    v_and_b32 v43, 0xffff0000, v137
    v_lshlrev_b32 v44, 16, v138
    v_and_b32 v45, 0xffff0000, v138
    v_lshlrev_b32 v46, 16, v139
    v_and_b32 v47, 0xffff0000, v139
    v_lshlrev_b32 v48, 16, v140
    v_and_b32 v49, 0xffff0000, v140
    v_lshlrev_b32 v50, 16, v141
    v_and_b32 v51, 0xffff0000, v141
    v_lshlrev_b32 v52, 16, v142
    v_and_b32 v53, 0xffff0000, v142
    v_lshlrev_b32 v54, 16, v143
    v_and_b32 v55, 0xffff0000, v143
    v_lshlrev_b32 v56, 16, v144
    v_and_b32 v57, 0xffff0000, v144
    v_lshlrev_b32 v58, 16, v145
    v_and_b32 v59, 0xffff0000, v145
    v_lshlrev_b32 v60, 16, v146
    v_and_b32 v61, 0xffff0000, v146
    v_lshlrev_b32 v62, 16, v147
    v_and_b32 v63, 0xffff0000, v147
    v_lshlrev_b32 v64, 16, v148
    v_and_b32 v65, 0xffff0000, v148
    v_lshlrev_b32 v66, 16, v149
    v_and_b32 v67, 0xffff0000, v149
    v_lshlrev_b32 v68, 16, v150
    v_and_b32 v69, 0xffff0000, v150
    v_lshlrev_b32 v70, 16, v151
    v_and_b32 v71, 0xffff0000, v151
    v_mov_b32 v8, 0
    v_mov_b32 v9, 0
    v_mov_b32 v10, 0
    v_mov_b32 v11, 0
    v_mov_b32 v12, 0
    v_mov_b32 v13, 0
    v_mov_b32 v14, 0
    v_mov_b32 v15, 0
    v_mov_b32 v16, 0
    v_mov_b32 v17, 0
    v_mov_b32 v18, 0
    v_mov_b32 v19, 0
    v_mov_b32 v20, 0
    v_mov_b32 v21, 0
    v_mov_b32 v22, 0
    v_mov_b32 v23, 0
    v_mov_b32 v24, 0
    v_mov_b32 v25, 0
    v_mov_b32 v26, 0
    v_mov_b32 v27, 0
    v_mov_b32 v28, 0
    v_mov_b32 v29, 0
    v_mov_b32 v30, 0
    v_mov_b32 v31, 0
    v_mov_b32 v32, 0
    v_mov_b32 v33, 0
    v_mov_b32 v34, 0
    v_mov_b32 v35, 0
    v_mov_b32 v36, 0
    v_mov_b32 v37, 0
    v_mov_b32 v38, 0
    v_mov_b32 v39, 0
    s_branch L_dn_x1
L_dn_x0:
    v_lshlrev_b32 v8, 16, v136
    v_and_b32 v9, 0xffff0000, v136
    v_lshlrev_b32 v10, 16, v137
    v_and_b32 v11, 0xffff0000, v137
    v_lshlrev_b32 v12, 16, v138
    v_and_b32 v13, 0xffff0000, v138
    v_lshlrev_b32 v14, 16, v139
    v_and_b32 v15, 0xffff0000, v139
    v_lshlrev_b32 v16, 16, v140
    v_and_b32 v17, 0xffff0000, v140
    v_lshlrev_b32 v18, 16, v141
    v_and_b32 v19, 0xffff0000, v141
    v_lshlrev_b32 v20, 16, v142
    v_and_b32 v21, 0xffff0000, v142
    v_lshlrev_b32 v22, 16, v143
    v_and_b32 v23, 0xffff0000, v143
    v_lshlrev_b32 v24, 16, v144
    v_and_b32 v25, 0xffff0000, v144
    v_lshlrev_b32 v26, 16, v145
    v_and_b32 v27, 0xffff0000, v145
    v_lshlrev_b32 v28, 16, v146
    v_and_b32 v29, 0xffff0000, v146
    v_lshlrev_b32 v30, 16, v147
    v_and_b32 v31, 0xffff0000, v147
    v_lshlrev_b32 v32, 16, v148
    v_and_b32 v33, 0xffff0000, v148
    v_lshlrev_b32 v34, 16, v149
    v_and_b32 v35, 0xffff0000, v149
    v_lshlrev_b32 v36, 16, v150
    v_and_b32 v37, 0xffff0000, v150
    v_lshlrev_b32 v38, 16, v151
    v_and_b32 v39, 0xffff0000, v151
    v_mov_b32 v40, 0
    v_mov_b32 v41, 0
    v_mov_b32 v42, 0
    v_mov_b32 v43, 0
    v_mov_b32 v44, 0
    v_mov_b32 v45, 0
    v_mov_b32 v46, 0
    v_mov_b32 v47, 0
    v_mov_b32 v48, 0
    v_mov_b32 v49, 0
    v_mov_b32 v50, 0
    v_mov_b32 v51, 0
    v_mov_b32 v52, 0
    v_mov_b32 v53, 0
    v_mov_b32 v54, 0
    v_mov_b32 v55, 0
    v_mov_b32 v56, 0
    v_mov_b32 v57, 0
    v_mov_b32 v58, 0
    v_mov_b32 v59, 0
    v_mov_b32 v60, 0
    v_mov_b32 v61, 0
    v_mov_b32 v62, 0
    v_mov_b32 v63, 0
    v_mov_b32 v64, 0
    v_mov_b32 v65, 0
    v_mov_b32 v66, 0
    v_mov_b32 v67, 0
    v_mov_b32 v68, 0
    v_mov_b32 v69, 0
    v_mov_b32 v70, 0
    v_mov_b32 v71, 0
L_dn_x1:
    s_add_u32 m0, s28, 0
    s_nop 0
    buffer_load_dwordx4 v2, s[12:15], s23 offen lds
    s_add_u32 m0, m0, 0x400
    s_nop 0
    buffer_load_dwordx4 v3, s[12:15], s23 offen lds
    s_add_u32 s23, s23, 131072
    s_nop 0
    buffer_load_dwordx4 v[72:75], v0, s[8:11], s22 offen offset:0
    buffer_load_dwordx4 v[76:79], v0, s[8:11], s22 offen offset:512
    buffer_load_dwordx4 v[80:83], v1, s[8:11], s22 offen offset:0
    buffer_load_dwordx4 v[84:87], v1, s[8:11], s22 offen offset:512
    s_add_u32 s22, s22, 2048
    s_add_u32 m0, s28, 8192
    s_nop 0
    buffer_load_dwordx4 v2, s[12:15], s23 offen lds
    s_add_u32 m0, m0, 0x400
    s_nop 0
    buffer_load_dwordx4 v3, s[12:15], s23 offen lds
    s_add_u32 s23, s23, 131072
    s_nop 0
    buffer_load_dwordx4 v[88:91], v0, s[8:11], s22 offen offset:0
    buffer_load_dwordx4 v[92:95], v0, s[8:11], s22 offen offset:512
    buffer_load_dwordx4 v[96:99], v1, s[8:11], s22 offen offset:0
    buffer_load_dwordx4 v[100:103], v1, s[8:11], s22 offen offset:512
    s_add_u32 s22, s22, 2048
    s_add_u32 m0, s28, 16384
    s_nop 0
    buffer_load_dwordx4 v2, s[12:15], s23 offen lds
    s_add_u32 m0, m0, 0x400
    s_nop 0
    buffer_load_dwordx4 v3, s[12:15], s23 offen lds
    s_add_u32 s23, s23, 131072
    s_nop 0
    buffer_load_dwordx4 v[104:107], v0, s[8:11], s22 offen offset:0
    buffer_load_dwordx4 v[108:111], v0, s[8:11], s22 offen offset:512
    buffer_load_dwordx4 v[112:115], v1, s[8:11], s22 offen offset:0
    buffer_load_dwordx4 v[116:119], v1, s[8:11], s22 offen offset:512
    s_add_u32 s22, s22, 2048
    s_setprio 0
    s_waitcnt vmcnt(16)
    s_barrier
    ds_read_b64_tr_b16 v[136:137], v4 offset:0
    ds_read_b64_tr_b16 v[138:139], v4 offset:512
    ds_read_b64_tr_b16 v[144:145], v5 offset:0
    ds_read_b64_tr_b16 v[146:147], v5 offset:512
    ds_read_b64_tr_b16 v[140:141], v4 offset:2048
    ds_read_b64_tr_b16 v[142:143], v4 offset:2560
    ds_read_b64_tr_b16 v[148:149], v5 offset:2048
    ds_read_b64_tr_b16 v[150:151], v5 offset:2560
    s_waitcnt vmcnt(10)
    s_waitcnt lgkmcnt(0)
    s_barrier
    v_mfma_f32_32x32x16_bf16 v[8:23], v[136:139], v[72:75], v[8:23]
    ds_read_b64_tr_b16 v[152:153], v4 offset:8192
    ds_read_b64_tr_b16 v[154:155], v4 offset:8704
    v_mfma_f32_32x32x16_bf16 v[24:39], v[136:139], v[80:83], v[24:39]
    ds_read_b64_tr_b16 v[160:161], v5 offset:8192
    ds_read_b64_tr_b16 v[162:163], v5 offset:8704
    v_mfma_f32_32x32x16_bf16 v[40:55], v[144:147], v[72:75], v[40:55]
    ds_read_b64_tr_b16 v[156:157], v4 offset:10240
    ds_read_b64_tr_b16 v[158:159], v4 offset:10752
    v_mfma_f32_32x32x16_bf16 v[56:71], v[144:147], v[80:83], v[56:71]
    ds_read_b64_tr_b16 v[164:165], v5 offset:10240
    ds_read_b64_tr_b16 v[166:167], v5 offset:10752
    v_mfma_f32_32x32x16_bf16 v[8:23], v[140:143], v[76:79], v[8:23]
    s_add_u32 m0, s28, 24576
    s_nop 0
    buffer_load_dwordx4 v2, s[12:15], s23 offen lds
    s_add_u32 m0, m0, 0x400
    v_mfma_f32_32x32x16_bf16 v[24:39], v[140:143], v[84:87], v[24:39]
    buffer_load_dwordx4 v3, s[12:15], s23 offen lds
    s_add_u32 s23, s23, 131072
    buffer_load_dwordx4 v[120:123], v0, s[8:11], s22 offen offset:0
    v_mfma_f32_32x32x16_bf16 v[40:55], v[148:151], v[76:79], v[40:55]
    buffer_load_dwordx4 v[124:127], v0, s[8:11], s22 offen offset:512
    buffer_load_dwordx4 v[128:131], v1, s[8:11], s22 offen offset:0
    v_mfma_f32_32x32x16_bf16 v[56:71], v[148:151], v[84:87], v[56:71]
    buffer_load_dwordx4 v[132:135], v1, s[8:11], s22 offen offset:512
    s_add_u32 s22, s22, 2048
    s_waitcnt vmcnt(10)
    s_waitcnt lgkmcnt(0)
    s_barrier
    v_mfma_f32_32x32x16_bf16 v[8:23], v[152:155], v[88:91], v[8:23]
    ds_read_b64_tr_b16 v[136:137], v4 offset:16384
    ds_read_b64_tr_b16 v[138:139], v4 offset:16896
    v_mfma_f32_32x32x16_bf16 v[24:39], v[152:155], v[96:99], v[24:39]
    ds_read_b64_tr_b16 v[144:145], v5 offset:16384
    ds_read_b64_tr_b16 v[146:147], v5 offset:16896
    v_mfma_f32_32x32x16_bf16 v[40:55], v[160:163], v[88:91], v[40:55]
    ds_read_b64_tr_b16 v[140:141], v4 offset:18432
    ds_read_b64_tr_b16 v[142:143], v4 offset:18944
    v_mfma_f32_32x32x16_bf16 v[56:71], v[160:163], v[96:99], v[56:71]
    ds_read_b64_tr_b16 v[148:149], v5 offset:18432
    ds_read_b64_tr_b16 v[150:151], v5 offset:18944
    v_mfma_f32_32x32x16_bf16 v[8:23], v[156:159], v[92:95], v[8:23]
    s_add_u32 m0, s28, 0
    s_nop 0
    buffer_load_dwordx4 v2, s[12:15], s23 offen lds
    s_add_u32 m0, m0, 0x400
    v_mfma_f32_32x32x16_bf16 v[24:39], v[156:159], v[100:103], v[24:39]
    buffer_load_dwordx4 v3, s[12:15], s23 offen lds
    s_add_u32 s23, s23, 131072
    buffer_load_dwordx4 v[72:75], v0, s[8:11], s22 offen offset:0
    v_mfma_f32_32x32x16_bf16 v[40:55], v[164:167], v[92:95], v[40:55]
    buffer_load_dwordx4 v[76:79], v0, s[8:11], s22 offen offset:512
    buffer_load_dwordx4 v[80:83], v1, s[8:11], s22 offen offset:0
    v_mfma_f32_32x32x16_bf16 v[56:71], v[164:167], v[100:103], v[56:71]
    buffer_load_dwordx4 v[84:87], v1, s[8:11], s22 offen offset:512
    s_add_u32 s22, s22, 2048
    s_waitcnt vmcnt(10)
    s_waitcnt lgkmcnt(0)
    s_barrier
    v_mfma_f32_32x32x16_bf16 v[8:23], v[136:139], v[104:107], v[8:23]
    ds_read_b64_tr_b16 v[152:153], v4 offset:24576
    ds_read_b64_tr_b16 v[154:155], v4 offset:25088
    v_mfma_f32_32x32x16_bf16 v[24:39], v[136:139], v[112:115], v[24:39]
    ds_read_b64_tr_b16 v[160:161], v5 offset:24576
    ds_read_b64_tr_b16 v[162:163], v5 offset:25088
    v_mfma_f32_32x32x16_bf16 v[40:55], v[144:147], v[104:107], v[40:55]
    ds_read_b64_tr_b16 v[156:157], v4 offset:26624
    ds_read_b64_tr_b16 v[158:159], v4 offset:27136
    v_mfma_f32_32x32x16_bf16 v[56:71], v[144:147], v[112:115], v[56:71]
    ds_read_b64_tr_b16 v[164:165], v5 offset:26624
    ds_read_b64_tr_b16 v[166:167], v5 offset:27136
    v_mfma_f32_32x32x16_bf16 v[8:23], v[140:143], v[108:111], v[8:23]
    s_add_u32 m0, s28, 8192
    s_nop 0
    buffer_load_dwordx4 v2, s[12:15], s23 offen lds
    s_add_u32 m0, m0, 0x400
    v_mfma_f32_32x32x16_bf16 v[24:39], v[140:143], v[116:119], v[24:39]
    buffer_load_dwordx4 v3, s[12:15], s23 offen lds
    s_add_u32 s23, s23, 131072
    buffer_load_dwordx4 v[88:91], v0, s[8:11], s22 offen offset:0
    v_mfma_f32_32x32x16_bf16 v[40:55], v[148:151], v[108:111], v[40:55]
    buffer_load_dwordx4 v[92:95], v0, s[8:11], s22 offen offset:512
    buffer_load_dwordx4 v[96:99], v1, s[8:11], s22 offen offset:0
    v_mfma_f32_32x32x16_bf16 v[56:71], v[148:151], v[116:119], v[56:71]
    buffer_load_dwordx4 v[100:103], v1, s[8:11], s22 offen offset:512
    s_add_u32 s22, s22, 2048
    s_waitcnt vmcnt(10)
    s_waitcnt lgkmcnt(0)
    s_barrier
    v_mfma_f32_32x32x16_bf16 v[8:23], v[152:155], v[120:123], v[8:23]
    ds_read_b64_tr_b16 v[136:137], v4 offset:0
    ds_read_b64_tr_b16 v[138:139], v4 offset:512
    v_mfma_f32_32x32x16_bf16 v[24:39], v[152:155], v[128:131], v[24:39]
    ds_read_b64_tr_b16 v[144:145], v5 offset:0
    ds_read_b64_tr_b16 v[146:147], v5 offset:512
    v_mfma_f32_32x32x16_bf16 v[40:55], v[160:163], v[120:123], v[40:55]
    ds_read_b64_tr_b16 v[140:141], v4 offset:2048
    ds_read_b64_tr_b16 v[142:143], v4 offset:2560
    v_mfma_f32_32x32x16_bf16 v[56:71], v[160:163], v[128:131], v[56:71]
    ds_read_b64_tr_b16 v[148:149], v5 offset:2048
    ds_read_b64_tr_b16 v[150:151], v5 offset:2560
    v_mfma_f32_32x32x16_bf16 v[8:23], v[156:159], v[124:127], v[8:23]
    s_add_u32 m0, s28, 16384
    s_nop 0
    buffer_load_dwordx4 v2, s[12:15], s23 offen lds
    s_add_u32 m0, m0, 0x400
    v_mfma_f32_32x32x16_bf16 v[24:39], v[156:159], v[132:135], v[24:39]
    buffer_load_dwordx4 v3, s[12:15], s23 offen lds
    s_add_u32 s23, s23, 131072
    buffer_load_dwordx4 v[104:107], v0, s[8:11], s22 offen offset:0
    v_mfma_f32_32x32x16_bf16 v[40:55], v[164:167], v[124:127], v[40:55]
    buffer_load_dwordx4 v[108:111], v0, s[8:11], s22 offen offset:512
    buffer_load_dwordx4 v[112:115], v1, s[8:11], s22 offen offset:0
    v_mfma_f32_32x32x16_bf16 v[56:71], v[164:167], v[132:135], v[56:71]
    buffer_load_dwordx4 v[116:119], v1, s[8:11], s22 offen offset:512
    s_add_u32 s22, s22, 2048
    s_waitcnt vmcnt(10)
    s_waitcnt lgkmcnt(0)
    s_barrier
    v_mfma_f32_32x32x16_bf16 v[8:23], v[136:139], v[72:75], v[8:23]
    ds_read_b64_tr_b16 v[152:153], v4 offset:8192
    ds_read_b64_tr_b16 v[154:155], v4 offset:8704
    v_mfma_f32_32x32x16_bf16 v[24:39], v[136:139], v[80:83], v[24:39]
    ds_read_b64_tr_b16 v[160:161], v5 offset:8192
    ds_read_b64_tr_b16 v[162:163], v5 offset:8704
    v_mfma_f32_32x32x16_bf16 v[40:55], v[144:147], v[72:75], v[40:55]
    ds_read_b64_tr_b16 v[156:157], v4 offset:10240
    ds_read_b64_tr_b16 v[158:159], v4 offset:10752
    v_mfma_f32_32x32x16_bf16 v[56:71], v[144:147], v[80:83], v[56:71]
    ds_read_b64_tr_b16 v[164:165], v5 offset:10240
    ds_read_b64_tr_b16 v[166:167], v5 offset:10752
    v_mfma_f32_32x32x16_bf16 v[8:23], v[140:143], v[76:79], v[8:23]
    s_add_u32 m0, s28, 24576
    s_nop 0
    buffer_load_dwordx4 v2, s[12:15], s23 offen lds
    s_add_u32 m0, m0, 0x400
    v_mfma_f32_32x32x16_bf16 v[24:39], v[140:143], v[84:87], v[24:39]
    buffer_load_dwordx4 v3, s[12:15], s23 offen lds
    s_add_u32 s23, s23, 131072
    buffer_load_dwordx4 v[120:123], v0, s[8:11], s22 offen offset:0
    v_mfma_f32_32x32x16_bf16 v[40:55], v[148:151], v[76:79], v[40:55]
    buffer_load_dwordx4 v[124:127], v0, s[8:11], s22 offen offset:512
    buffer_load_dwordx4 v[128:131], v1, s[8:11], s22 offen offset:0
    v_mfma_f32_32x32x16_bf16 v[56:71], v[148:151], v[84:87], v[56:71]
    buffer_load_dwordx4 v[132:135], v1, s[8:11], s22 offen offset:512
    s_add_u32 s22, s22, 2048
    s_waitcnt vmcnt(10)
    s_waitcnt lgkmcnt(0)
    s_barrier
    v_mfma_f32_32x32x16_bf16 v[8:23], v[152:155], v[88:91], v[8:23]
    ds_read_b64_tr_b16 v[136:137], v4 offset:16384
    ds_read_b64_tr_b16 v[138:139], v4 offset:16896
    v_mfma_f32_32x32x16_bf16 v[24:39], v[152:155], v[96:99], v[24:39]
    ds_read_b64_tr_b16 v[144:145], v5 offset:16384
    ds_read_b64_tr_b16 v[146:147], v5 offset:16896
    v_mfma_f32_32x32x16_bf16 v[40:55], v[160:163], v[88:91], v[40:55]
    ds_read_b64_tr_b16 v[140:141], v4 offset:18432
    ds_read_b64_tr_b16 v[142:143], v4 offset:18944
    v_mfma_f32_32x32x16_bf16 v[56:71], v[160:163], v[96:99], v[56:71]
    ds_read_b64_tr_b16 v[148:149], v5 offset:18432
    ds_read_b64_tr_b16 v[150:151], v5 offset:18944
    v_mfma_f32_32x32x16_bf16 v[8:23], v[156:159], v[92:95], v[8:23]
    s_add_u32 m0, s28, 0
    s_nop 0
    buffer_load_dwordx4 v2, s[12:15], s23 offen lds
    s_add_u32 m0, m0, 0x400
    v_mfma_f32_32x32x16_bf16 v[24:39], v[156:159], v[100:103], v[24:39]
    buffer_load_dwordx4 v3, s[12:15], s23 offen lds
    s_add_u32 s23, s23, 131072
    buffer_load_dwordx4 v[72:75], v0, s[8:11], s22 offen offset:0
    v_mfma_f32_32x32x16_bf16 v[40:55], v[164:167], v[92:95], v[40:55]
    buffer_load_dwordx4 v[76:79], v0, s[8:11], s22 offen offset:512
    buffer_load_dwordx4 v[80:83], v1, s[8:11], s22 offen offset:0
    v_mfma_f32_32x32x16_bf16 v[56:71], v[164:167], v[100:103], v[56:71]
    buffer_load_dwordx4 v[84:87], v1, s[8:11], s22 offen offset:512
    s_add_u32 s22, s22, 2048
    s_waitcnt vmcnt(10)
    s_waitcnt lgkmcnt(0)
    s_barrier
    v_mfma_f32_32x32x16_bf16 v[8:23], v[136:139], v[104:107], v[8:23]
    ds_read_b64_tr_b16 v[152:153], v4 offset:24576
    ds_read_b64_tr_b16 v[154:155], v4 offset:25088
    v_mfma_f32_32x32x16_bf16 v[24:39], v[136:139], v[112:115], v[24:39]
    ds_read_b64_tr_b16 v[160:161], v5 offset:24576
    ds_read_b64_tr_b16 v[162:163], v5 offset:25088
    v_mfma_f32_32x32x16_bf16 v[40:55], v[144:147], v[104:107], v[40:55]
    ds_read_b64_tr_b16 v[156:157], v4 offset:26624
    ds_read_b64_tr_b16 v[158:159], v4 offset:27136
    v_mfma_f32_32x32x16_bf16 v[56:71], v[144:147], v[112:115], v[56:71]
    ds_read_b64_tr_b16 v[164:165], v5 offset:26624
    ds_read_b64_tr_b16 v[166:167], v5 offset:27136
    v_mfma_f32_32x32x16_bf16 v[8:23], v[140:143], v[108:111], v[8:23]
    s_add_u32 m0, s28, 8192
    s_nop 0
    buffer_load_dwordx4 v2, s[12:15], s23 offen lds
    s_add_u32 m0, m0, 0x400
    v_mfma_f32_32x32x16_bf16 v[24:39], v[140:143], v[116:119], v[24:39]
    buffer_load_dwordx4 v3, s[12:15], s23 offen lds
    s_add_u32 s23, s23, 131072
    buffer_load_dwordx4 v[88:91], v0, s[8:11], s22 offen offset:0
    v_mfma_f32_32x32x16_bf16 v[40:55], v[148:151], v[108:111], v[40:55]
    buffer_load_dwordx4 v[92:95], v0, s[8:11], s22 offen offset:512
    buffer_load_dwordx4 v[96:99], v1, s[8:11], s22 offen offset:0
    v_mfma_f32_32x32x16_bf16 v[56:71], v[148:151], v[116:119], v[56:71]
    buffer_load_dwordx4 v[100:103], v1, s[8:11], s22 offen offset:512
    s_add_u32 s22, s22, 2048
    s_waitcnt vmcnt(10)
    s_waitcnt lgkmcnt(0)
    s_barrier
    v_mfma_f32_32x32x16_bf16 v[8:23], v[152:155], v[120:123], v[8:23]
    ds_read_b64_tr_b16 v[136:137], v4 offset:0
    ds_read_b64_tr_b16 v[138:139], v4 offset:512
    v_mfma_f32_32x32x16_bf16 v[24:39], v[152:155], v[128:131], v[24:39]
    ds_read_b64_tr_b16 v[144:145], v5 offset:0
    ds_read_b64_tr_b16 v[146:147], v5 offset:512
    v_mfma_f32_32x32x16_bf16 v[40:55], v[160:163], v[120:123], v[40:55]
    ds_read_b64_tr_b16 v[140:141], v4 offset:2048
    ds_read_b64_tr_b16 v[142:143], v4 offset:2560
    v_mfma_f32_32x32x16_bf16 v[56:71], v[160:163], v[128:131], v[56:71]
    ds_read_b64_tr_b16 v[148:149], v5 offset:2048
    ds_read_b64_tr_b16 v[150:151], v5 offset:2560
    v_mfma_f32_32x32x16_bf16 v[8:23], v[156:159], v[124:127], v[8:23]
    s_add_u32 m0, s28, 16384
    s_nop 0
    buffer_load_dwordx4 v2, s[12:15], s23 offen lds
    s_add_u32 m0, m0, 0x400
    v_mfma_f32_32x32x16_bf16 v[24:39], v[156:159], v[132:135], v[24:39]
    buffer_load_dwordx4 v3, s[12:15], s23 offen lds
    s_add_u32 s23, s23, 131072
    buffer_load_dwordx4 v[104:107], v0, s[8:11], s22 offen offset:0
    v_mfma_f32_32x32x16_bf16 v[40:55], v[164:167], v[124:127], v[40:55]
    buffer_load_dwordx4 v[108:111], v0, s[8:11], s22 offen offset:512
    buffer_load_dwordx4 v[112:115], v1, s[8:11], s22 offen offset:0
    v_mfma_f32_32x32x16_bf16 v[56:71], v[164:167], v[132:135], v[56:71]
    buffer_load_dwordx4 v[116:119], v1, s[8:11], s22 offen offset:512
    s_add_u32 s22, s22, 2048
    s_mov_b32 s21, 3
L_dn_loop:
    s_waitcnt vmcnt(10)
    s_waitcnt lgkmcnt(0)
    s_barrier
    v_mfma_f32_32x32x16_bf16 v[8:23], v[136:139], v[72:75], v[8:23]
    ds_read_b64_tr_b16 v[152:153], v4 offset:8192
    ds_read_b64_tr_b16 v[154:155], v4 offset:8704
    v_mfma_f32_32x32x16_bf16 v[24:39], v[136:139], v[80:83], v[24:39]
    ds_read_b64_tr_b16 v[160:161], v5 offset:8192
    ds_read_b64_tr_b16 v[162:163], v5 offset:8704
    v_mfma_f32_32x32x16_bf16 v[40:55], v[144:147], v[72:75], v[40:55]
    ds_read_b64_tr_b16 v[156:157], v4 offset:10240
    ds_read_b64_tr_b16 v[158:159], v4 offset:10752
    v_mfma_f32_32x32x16_bf16 v[56:71], v[144:147], v[80:83], v[56:71]
    ds_read_b64_tr_b16 v[164:165], v5 offset:10240
    ds_read_b64_tr_b16 v[166:167], v5 offset:10752
    v_mfma_f32_32x32x16_bf16 v[8:23], v[140:143], v[76:79], v[8:23]
    s_add_u32 m0, s28, 24576
    s_nop 0
    buffer_load_dwordx4 v2, s[12:15], s23 offen lds
    s_add_u32 m0, m0, 0x400
    v_mfma_f32_32x32x16_bf16 v[24:39], v[140:143], v[84:87], v[24:39]
    buffer_load_dwordx4 v3, s[12:15], s23 offen lds
    s_add_u32 s23, s23, 131072
    buffer_load_dwordx4 v[120:123], v0, s[8:11], s22 offen offset:0
    v_mfma_f32_32x32x16_bf16 v[40:55], v[148:151], v[76:79], v[40:55]
    buffer_load_dwordx4 v[124:127], v0, s[8:11], s22 offen offset:512
    buffer_load_dwordx4 v[128:131], v1, s[8:11], s22 offen offset:0
    v_mfma_f32_32x32x16_bf16 v[56:71], v[148:151], v[84:87], v[56:71]
    buffer_load_dwordx4 v[132:135], v1, s[8:11], s22 offen offset:512
    s_add_u32 s22, s22, 2048
    s_waitcnt vmcnt(10)
    s_waitcnt lgkmcnt(0)
    s_barrier
    v_mfma_f32_32x32x16_bf16 v[8:23], v[152:155], v[88:91], v[8:23]
    ds_read_b64_tr_b16 v[136:137], v4 offset:16384
    ds_read_b64_tr_b16 v[138:139], v4 offset:16896
    v_mfma_f32_32x32x16_bf16 v[24:39], v[152:155], v[96:99], v[24:39]
    ds_read_b64_tr_b16 v[144:145], v5 offset:16384
    ds_read_b64_tr_b16 v[146:147], v5 offset:16896
    v_mfma_f32_32x32x16_bf16 v[40:55], v[160:163], v[88:91], v[40:55]
    ds_read_b64_tr_b16 v[140:141], v4 offset:18432
    ds_read_b64_tr_b16 v[142:143], v4 offset:18944
    v_mfma_f32_32x32x16_bf16 v[56:71], v[160:163], v[96:99], v[56:71]
    ds_read_b64_tr_b16 v[148:149], v5 offset:18432
    ds_read_b64_tr_b16 v[150:151], v5 offset:18944
    v_mfma_f32_32x32x16_bf16 v[8:23], v[156:159], v[92:95], v[8:23]
    s_add_u32 m0, s28, 0
    s_nop 0
    buffer_load_dwordx4 v2, s[12:15], s23 offen lds
    s_add_u32 m0, m0, 0x400
    v_mfma_f32_32x32x16_bf16 v[24:39], v[156:159], v[100:103], v[24:39]
    buffer_load_dwordx4 v3, s[12:15], s23 offen lds
    s_add_u32 s23, s23, 131072
    buffer_load_dwordx4 v[72:75], v0, s[8:11], s22 offen offset:0
    v_mfma_f32_32x32x16_bf16 v[40:55], v[164:167], v[92:95], v[40:55]
    buffer_load_dwordx4 v[76:79], v0, s[8:11], s22 offen offset:512
    buffer_load_dwordx4 v[80:83], v1, s[8:11], s22 offen offset:0
    v_mfma_f32_32x32x16_bf16 v[56:71], v[164:167], v[100:103], v[56:71]
    buffer_load_dwordx4 v[84:87], v1, s[8:11], s22 offen offset:512
    s_add_u32 s22, s22, 2048
    s_waitcnt vmcnt(10)
    s_waitcnt lgkmcnt(0)
    s_barrier
    v_mfma_f32_32x32x16_bf16 v[8:23], v[136:139], v[104:107], v[8:23]
    ds_read_b64_tr_b16 v[152:153], v4 offset:24576
    ds_read_b64_tr_b16 v[154:155], v4 offset:25088
    v_mfma_f32_32x32x16_bf16 v[24:39], v[136:139], v[112:115], v[24:39]
    ds_read_b64_tr_b16 v[160:161], v5 offset:24576
    ds_read_b64_tr_b16 v[162:163], v5 offset:25088
    v_mfma_f32_32x32x16_bf16 v[40:55], v[144:147], v[104:107], v[40:55]
    ds_read_b64_tr_b16 v[156:157], v4 offset:26624
    ds_read_b64_tr_b16 v[158:159], v4 offset:27136
    v_mfma_f32_32x32x16_bf16 v[56:71], v[144:147], v[112:115], v[56:71]
    ds_read_b64_tr_b16 v[164:165], v5 offset:26624
    ds_read_b64_tr_b16 v[166:167], v5 offset:27136
    v_mfma_f32_32x32x16_bf16 v[8:23], v[140:143], v[108:111], v[8:23]
    s_add_u32 m0, s28, 8192
    s_nop 0
    buffer_load_dwordx4 v2, s[12:15], s23 offen lds
    s_add_u32 m0, m0, 0x400
    v_mfma_f32_32x32x16_bf16 v[24:39], v[140:143], v[116:119], v[24:39]
    buffer_load_dwordx4 v3, s[12:15], s23 offen lds
    s_add_u32 s23, s23, 131072
    buffer_load_dwordx4 v[88:91], v0, s[8:11], s22 offen offset:0
    v_mfma_f32_32x32x16_bf16 v[40:55], v[148:151], v[108:111], v[40:55]
    buffer_load_dwordx4 v[92:95], v0, s[8:11], s22 offen offset:512
    buffer_load_dwordx4 v[96:99], v1, s[8:11], s22 offen offset:0
    v_mfma_f32_32x32x16_bf16 v[56:71], v[148:151], v[116:119], v[56:71]
    buffer_load_dwordx4 v[100:103], v1, s[8:11], s22 offen offset:512
    s_add_u32 s22, s22, 2048
    s_waitcnt vmcnt(10)
    s_waitcnt lgkmcnt(0)
    s_barrier
    v_mfma_f32_32x32x16_bf16 v[8:23], v[152:155], v[120:123], v[8:23]
    ds_read_b64_tr_b16 v[136:137], v4 offset:0
    ds_read_b64_tr_b16 v[138:139], v4 offset:512
    v_mfma_f32_32x32x16_bf16 v[24:39], v[152:155], v[128:131], v[24:39]
    ds_read_b64_tr_b16 v[144:145], v5 offset:0
    ds_read_b64_tr_b16 v[146:147], v5 offset:512
    v_mfma_f32_32x32x16_bf16 v[40:55], v[160:163], v[120:123], v[40:55]
    ds_read_b64_tr_b16 v[140:141], v4 offset:2048
    ds_read_b64_tr_b16 v[142:143], v4 offset:2560
    v_mfma_f32_32x32x16_bf16 v[56:71], v[160:163], v[128:131], v[56:71]
    ds_read_b64_tr_b16 v[148:149], v5 offset:2048
    ds_read_b64_tr_b16 v[150:151], v5 offset:2560
    v_mfma_f32_32x32x16_bf16 v[8:23], v[156:159], v[124:127], v[8:23]
    s_add_u32 m0, s28, 16384
    s_nop 0
    buffer_load_dwordx4 v2, s[12:15], s23 offen lds
    s_add_u32 m0, m0, 0x400
    v_mfma_f32_32x32x16_bf16 v[24:39], v[156:159], v[132:135], v[24:39]
    buffer_load_dwordx4 v3, s[12:15], s23 offen lds
    s_add_u32 s23, s23, 131072
    buffer_load_dwordx4 v[104:107], v0, s[8:11], s22 offen offset:0
    v_mfma_f32_32x32x16_bf16 v[40:55], v[164:167], v[124:127], v[40:55]
    buffer_load_dwordx4 v[108:111], v0, s[8:11], s22 offen offset:512
    buffer_load_dwordx4 v[112:115], v1, s[8:11], s22 offen offset:0
    v_mfma_f32_32x32x16_bf16 v[56:71], v[164:167], v[132:135], v[56:71]
    buffer_load_dwordx4 v[116:119], v1, s[8:11], s22 offen offset:512
    s_add_u32 s22, s22, 2048
    s_waitcnt vmcnt(10)
    s_waitcnt lgkmcnt(0)
    s_barrier
    v_mfma_f32_32x32x16_bf16 v[8:23], v[136:139], v[72:75], v[8:23]
    ds_read_b64_tr_b16 v[152:153], v4 offset:8192
    ds_read_b64_tr_b16 v[154:155], v4 offset:8704
    v_mfma_f32_32x32x16_bf16 v[24:39], v[136:139], v[80:83], v[24:39]
    ds_read_b64_tr_b16 v[160:161], v5 offset:8192
    ds_read_b64_tr_b16 v[162:163], v5 offset:8704
    v_mfma_f32_32x32x16_bf16 v[40:55], v[144:147], v[72:75], v[40:55]
    ds_read_b64_tr_b16 v[156:157], v4 offset:10240
    ds_read_b64_tr_b16 v[158:159], v4 offset:10752
    v_mfma_f32_32x32x16_bf16 v[56:71], v[144:147], v[80:83], v[56:71]
    ds_read_b64_tr_b16 v[164:165], v5 offset:10240
    ds_read_b64_tr_b16 v[166:167], v5 offset:10752
    v_mfma_f32_32x32x16_bf16 v[8:23], v[140:143], v[76:79], v[8:23]
    s_add_u32 m0, s28, 24576
    s_nop 0
    buffer_load_dwordx4 v2, s[12:15], s23 offen lds
    s_add_u32 m0, m0, 0x400
    v_mfma_f32_32x32x16_bf16 v[24:39], v[140:143], v[84:87], v[24:39]
    buffer_load_dwordx4 v3, s[12:15], s23 offen lds
    s_add_u32 s23, s23, 131072
    buffer_load_dwordx4 v[120:123], v0, s[8:11], s22 offen offset:0
    v_mfma_f32_32x32x16_bf16 v[40:55], v[148:151], v[76:79], v[40:55]
    buffer_load_dwordx4 v[124:127], v0, s[8:11], s22 offen offset:512
    buffer_load_dwordx4 v[128:131], v1, s[8:11], s22 offen offset:0
    v_mfma_f32_32x32x16_bf16 v[56:71], v[148:151], v[84:87], v[56:71]
    buffer_load_dwordx4 v[132:135], v1, s[8:11], s22 offen offset:512
    s_add_u32 s22, s22, 2048
    s_waitcnt vmcnt(10)
    s_waitcnt lgkmcnt(0)
    s_barrier
    v_mfma_f32_32x32x16_bf16 v[8:23], v[152:155], v[88:91], v[8:23]
    ds_read_b64_tr_b16 v[136:137], v4 offset:16384
    ds_read_b64_tr_b16 v[138:139], v4 offset:16896
    v_mfma_f32_32x32x16_bf16 v[24:39], v[152:155], v[96:99], v[24:39]
    ds_read_b64_tr_b16 v[144:145], v5 offset:16384
    ds_read_b64_tr_b16 v[146:147], v5 offset:16896
    v_mfma_f32_32x32x16_bf16 v[40:55], v[160:163], v[88:91], v[40:55]
    ds_read_b64_tr_b16 v[140:141], v4 offset:18432
    ds_read_b64_tr_b16 v[142:143], v4 offset:18944
    v_mfma_f32_32x32x16_bf16 v[56:71], v[160:163], v[96:99], v[56:71]
    ds_read_b64_tr_b16 v[148:149], v5 offset:18432
    ds_read_b64_tr_b16 v[150:151], v5 offset:18944
    v_mfma_f32_32x32x16_bf16 v[8:23], v[156:159], v[92:95], v[8:23]
    s_add_u32 m0, s28, 0
    s_nop 0
    buffer_load_dwordx4 v2, s[12:15], s23 offen lds
    s_add_u32 m0, m0, 0x400
    v_mfma_f32_32x32x16_bf16 v[24:39], v[156:159], v[100:103], v[24:39]
    buffer_load_dwordx4 v3, s[12:15], s23 offen lds
    s_add_u32 s23, s23, 131072
    buffer_load_dwordx4 v[72:75], v0, s[8:11], s22 offen offset:0
    v_mfma_f32_32x32x16_bf16 v[40:55], v[164:167], v[92:95], v[40:55]
    buffer_load_dwordx4 v[76:79], v0, s[8:11], s22 offen offset:512
    buffer_load_dwordx4 v[80:83], v1, s[8:11], s22 offen offset:0
    v_mfma_f32_32x32x16_bf16 v[56:71], v[164:167], v[100:103], v[56:71]
    buffer_load_dwordx4 v[84:87], v1, s[8:11], s22 offen offset:512
    s_add_u32 s22, s22, 2048
    s_waitcnt vmcnt(10)
    s_waitcnt lgkmcnt(0)
    s_barrier
    v_mfma_f32_32x32x16_bf16 v[8:23], v[136:139], v[104:107], v[8:23]
    ds_read_b64_tr_b16 v[152:153], v4 offset:24576
    ds_read_b64_tr_b16 v[154:155], v4 offset:25088
    v_mfma_f32_32x32x16_bf16 v[24:39], v[136:139], v[112:115], v[24:39]
    ds_read_b64_tr_b16 v[160:161], v5 offset:24576
    ds_read_b64_tr_b16 v[162:163], v5 offset:25088
    v_mfma_f32_32x32x16_bf16 v[40:55], v[144:147], v[104:107], v[40:55]
    ds_read_b64_tr_b16 v[156:157], v4 offset:26624
    ds_read_b64_tr_b16 v[158:159], v4 offset:27136
    v_mfma_f32_32x32x16_bf16 v[56:71], v[144:147], v[112:115], v[56:71]
    ds_read_b64_tr_b16 v[164:165], v5 offset:26624
    ds_read_b64_tr_b16 v[166:167], v5 offset:27136
    v_mfma_f32_32x32x16_bf16 v[8:23], v[140:143], v[108:111], v[8:23]
    s_add_u32 m0, s28, 8192
    s_nop 0
    buffer_load_dwordx4 v2, s[12:15], s23 offen lds
    s_add_u32 m0, m0, 0x400
    v_mfma_f32_32x32x16_bf16 v[24:39], v[140:143], v[116:119], v[24:39]
    buffer_load_dwordx4 v3, s[12:15], s23 offen lds
    s_add_u32 s23, s23, 131072
    buffer_load_dwordx4 v[88:91], v0, s[8:11], s22 offen offset:0
    v_mfma_f32_32x32x16_bf16 v[40:55], v[148:151], v[108:111], v[40:55]
    buffer_load_dwordx4 v[92:95], v0, s[8:11], s22 offen offset:512
    buffer_load_dwordx4 v[96:99], v1, s[8:11], s22 offen offset:0
    v_mfma_f32_32x32x16_bf16 v[56:71], v[148:151], v[116:119], v[56:71]
    buffer_load_dwordx4 v[100:103], v1, s[8:11], s22 offen offset:512
    s_add_u32 s22, s22, 2048
    s_waitcnt vmcnt(10)
    s_waitcnt lgkmcnt(0)
    s_barrier
    v_mfma_f32_32x32x16_bf16 v[8:23], v[152:155], v[120:123], v[8:23]
    ds_read_b64_tr_b16 v[136:137], v4 offset:0
    ds_read_b64_tr_b16 v[138:139], v4 offset:512
    v_mfma_f32_32x32x16_bf16 v[24:39], v[152:155], v[128:131], v[24:39]
    ds_read_b64_tr_b16 v[144:145], v5 offset:0
    ds_read_b64_tr_b16 v[146:147], v5 offset:512
    v_mfma_f32_32x32x16_bf16 v[40:55], v[160:163], v[120:123], v[40:55]
    ds_read_b64_tr_b16 v[140:141], v4 offset:2048
    ds_read_b64_tr_b16 v[142:143], v4 offset:2560
    v_mfma_f32_32x32x16_bf16 v[56:71], v[160:163], v[128:131], v[56:71]
    ds_read_b64_tr_b16 v[148:149], v5 offset:2048
    ds_read_b64_tr_b16 v[150:151], v5 offset:2560
    v_mfma_f32_32x32x16_bf16 v[8:23], v[156:159], v[124:127], v[8:23]
    s_add_u32 m0, s28, 16384
    s_nop 0
    buffer_load_dwordx4 v2, s[12:15], s23 offen lds
    s_add_u32 m0, m0, 0x400
    v_mfma_f32_32x32x16_bf16 v[24:39], v[156:159], v[132:135], v[24:39]
    buffer_load_dwordx4 v3, s[12:15], s23 offen lds
    s_add_u32 s23, s23, 131072
    buffer_load_dwordx4 v[104:107], v0, s[8:11], s22 offen offset:0
    v_mfma_f32_32x32x16_bf16 v[40:55], v[164:167], v[124:127], v[40:55]
    buffer_load_dwordx4 v[108:111], v0, s[8:11], s22 offen offset:512
    buffer_load_dwordx4 v[112:115], v1, s[8:11], s22 offen offset:0
    v_mfma_f32_32x32x16_bf16 v[56:71], v[164:167], v[132:135], v[56:71]
    buffer_load_dwordx4 v[116:119], v1, s[8:11], s22 offen offset:512
    s_add_u32 s22, s22, 2048
    s_waitcnt vmcnt(10)
    s_waitcnt lgkmcnt(0)
    s_barrier
    v_mfma_f32_32x32x16_bf16 v[8:23], v[136:139], v[72:75], v[8:23]
    ds_read_b64_tr_b16 v[152:153], v4 offset:8192
    ds_read_b64_tr_b16 v[154:155], v4 offset:8704
    v_mfma_f32_32x32x16_bf16 v[24:39], v[136:139], v[80:83], v[24:39]
    ds_read_b64_tr_b16 v[160:161], v5 offset:8192
    ds_read_b64_tr_b16 v[162:163], v5 offset:8704
    v_mfma_f32_32x32x16_bf16 v[40:55], v[144:147], v[72:75], v[40:55]
    ds_read_b64_tr_b16 v[156:157], v4 offset:10240
    ds_read_b64_tr_b16 v[158:159], v4 offset:10752
    v_mfma_f32_32x32x16_bf16 v[56:71], v[144:147], v[80:83], v[56:71]
    ds_read_b64_tr_b16 v[164:165], v5 offset:10240
    ds_read_b64_tr_b16 v[166:167], v5 offset:10752
    v_mfma_f32_32x32x16_bf16 v[8:23], v[140:143], v[76:79], v[8:23]
    s_add_u32 m0, s28, 24576
    s_nop 0
    buffer_load_dwordx4 v2, s[12:15], s23 offen lds
    s_add_u32 m0, m0, 0x400
    v_mfma_f32_32x32x16_bf16 v[24:39], v[140:143], v[84:87], v[24:39]
    buffer_load_dwordx4 v3, s[12:15], s23 offen lds
    s_add_u32 s23, s23, 131072
    buffer_load_dwordx4 v[120:123], v0, s[8:11], s22 offen offset:0
    v_mfma_f32_32x32x16_bf16 v[40:55], v[148:151], v[76:79], v[40:55]
    buffer_load_dwordx4 v[124:127], v0, s[8:11], s22 offen offset:512
    buffer_load_dwordx4 v[128:131], v1, s[8:11], s22 offen offset:0
    v_mfma_f32_32x32x16_bf16 v[56:71], v[148:151], v[84:87], v[56:71]
    buffer_load_dwordx4 v[132:135], v1, s[8:11], s22 offen offset:512
    s_add_u32 s22, s22, 2048
    s_waitcnt vmcnt(10)
    s_waitcnt lgkmcnt(0)
    s_barrier
    v_mfma_f32_32x32x16_bf16 v[8:23], v[152:155], v[88:91], v[8:23]
    ds_read_b64_tr_b16 v[136:137], v4 offset:16384
    ds_read_b64_tr_b16 v[138:139], v4 offset:16896
    v_mfma_f32_32x32x16_bf16 v[24:39], v[152:155], v[96:99], v[24:39]
    ds_read_b64_tr_b16 v[144:145], v5 offset:16384
    ds_read_b64_tr_b16 v[146:147], v5 offset:16896
    v_mfma_f32_32x32x16_bf16 v[40:55], v[160:163], v[88:91], v[40:55]
    ds_read_b64_tr_b16 v[140:141], v4 offset:18432
    ds_read_b64_tr_b16 v[142:143], v4 offset:18944
    v_mfma_f32_32x32x16_bf16 v[56:71], v[160:163], v[96:99], v[56:71]
    ds_read_b64_tr_b16 v[148:149], v5 offset:18432
    ds_read_b64_tr_b16 v[150:151], v5 offset:18944
    v_mfma_f32_32x32x16_bf16 v[8:23], v[156:159], v[92:95], v[8:23]
    s_add_u32 m0, s28, 0
    s_nop 0
    buffer_load_dwordx4 v2, s[12:15], s23 offen lds
    s_add_u32 m0, m0, 0x400
    v_mfma_f32_32x32x16_bf16 v[24:39], v[156:159], v[100:103], v[24:39]
    buffer_load_dwordx4 v3, s[12:15], s23 offen lds
    s_add_u32 s23, s23, 131072
    buffer_load_dwordx4 v[72:75], v0, s[8:11], s22 offen offset:0
    v_mfma_f32_32x32x16_bf16 v[40:55], v[164:167], v[92:95], v[40:55]
    buffer_load_dwordx4 v[76:79], v0, s[8:11], s22 offen offset:512
    buffer_load_dwordx4 v[80:83], v1, s[8:11], s22 offen offset:0
    v_mfma_f32_32x32x16_bf16 v[56:71], v[164:167], v[100:103], v[56:71]
    buffer_load_dwordx4 v[84:87], v1, s[8:11], s22 offen offset:512
    s_add_u32 s22, s22, 2048
    s_waitcnt vmcnt(10)
    s_waitcnt lgkmcnt(0)
    s_barrier
    v_mfma_f32_32x32x16_bf16 v[8:23], v[136:139], v[104:107], v[8:23]
    ds_read_b64_tr_b16 v[152:153], v4 offset:24576
    ds_read_b64_tr_b16 v[154:155], v4 offset:25088
    v_mfma_f32_32x32x16_bf16 v[24:39], v[136:139], v[112:115], v[24:39]
    ds_read_b64_tr_b16 v[160:161], v5 offset:24576
    ds_read_b64_tr_b16 v[162:163], v5 offset:25088
    v_mfma_f32_32x32x16_bf16 v[40:55], v[144:147], v[104:107], v[40:55]
    ds_read_b64_tr_b16 v[156:157], v4 offset:26624
    ds_read_b64_tr_b16 v[158:159], v4 offset:27136
    v_mfma_f32_32x32x16_bf16 v[56:71], v[144:147], v[112:115], v[56:71]
    ds_read_b64_tr_b16 v[164:165], v5 offset:26624
    ds_read_b64_tr_b16 v[166:167], v5 offset:27136
    v_mfma_f32_32x32x16_bf16 v[8:23], v[140:143], v[108:111], v[8:23]
    s_add_u32 m0, s28, 8192
    s_nop 0
    buffer_load_dwordx4 v2, s[12:15], s23 offen lds
    s_add_u32 m0, m0, 0x400
    v_mfma_f32_32x32x16_bf16 v[24:39], v[140:143], v[116:119], v[24:39]
    buffer_load_dwordx4 v3, s[12:15], s23 offen lds
    s_add_u32 s23, s23, 131072
    buffer_load_dwordx4 v[88:91], v0, s[8:11], s22 offen offset:0
    v_mfma_f32_32x32x16_bf16 v[40:55], v[148:151], v[108:111], v[40:55]
    buffer_load_dwordx4 v[92:95], v0, s[8:11], s22 offen offset:512
    buffer_load_dwordx4 v[96:99], v1, s[8:11], s22 offen offset:0
    v_mfma_f32_32x32x16_bf16 v[56:71], v[148:151], v[116:119], v[56:71]
    buffer_load_dwordx4 v[100:103], v1, s[8:11], s22 offen offset:512
    s_add_u32 s22, s22, 2048
    s_waitcnt vmcnt(10)
    s_waitcnt lgkmcnt(0)
    s_barrier
    v_mfma_f32_32x32x16_bf16 v[8:23], v[152:155], v[120:123], v[8:23]
    ds_read_b64_tr_b16 v[136:137], v4 offset:0
    ds_read_b64_tr_b16 v[138:139], v4 offset:512
    v_mfma_f32_32x32x16_bf16 v[24:39], v[152:155], v[128:131], v[24:39]
    ds_read_b64_tr_b16 v[144:145], v5 offset:0
    ds_read_b64_tr_b16 v[146:147], v5 offset:512
    v_mfma_f32_32x32x16_bf16 v[40:55], v[160:163], v[120:123], v[40:55]
    ds_read_b64_tr_b16 v[140:141], v4 offset:2048
    ds_read_b64_tr_b16 v[142:143], v4 offset:2560
    v_mfma_f32_32x32x16_bf16 v[56:71], v[160:163], v[128:131], v[56:71]
    ds_read_b64_tr_b16 v[148:149], v5 offset:2048
    ds_read_b64_tr_b16 v[150:151], v5 offset:2560
    v_mfma_f32_32x32x16_bf16 v[8:23], v[156:159], v[124:127], v[8:23]
    s_add_u32 m0, s28, 16384
    s_nop 0
    buffer_load_dwordx4 v2, s[12:15], s23 offen lds
    s_add_u32 m0, m0, 0x400
    v_mfma_f32_32x32x16_bf16 v[24:39], v[156:159], v[132:135], v[24:39]
    buffer_load_dwordx4 v3, s[12:15], s23 offen lds
    s_add_u32 s23, s23, 131072
    buffer_load_dwordx4 v[104:107], v0, s[8:11], s22 offen offset:0
    v_mfma_f32_32x32x16_bf16 v[40:55], v[164:167], v[124:127], v[40:55]
    buffer_load_dwordx4 v[108:111], v0, s[8:11], s22 offen offset:512
    buffer_load_dwordx4 v[112:115], v1, s[8:11], s22 offen offset:0
    v_mfma_f32_32x32x16_bf16 v[56:71], v[164:167], v[132:135], v[56:71]
    buffer_load_dwordx4 v[116:119], v1, s[8:11], s22 offen offset:512
    s_add_u32 s22, s22, 2048
    s_sub_u32 s21, s21, 1
    s_cmp_lg_u32 s21, 0
    s_cbranch_scc1 L_dn_loop
    s_waitcnt vmcnt(10)
    s_waitcnt lgkmcnt(0)
    s_barrier
    v_mfma_f32_32x32x16_bf16 v[8:23], v[136:139], v[72:75], v[8:23]
    ds_read_b64_tr_b16 v[152:153], v4 offset:8192
    ds_read_b64_tr_b16 v[154:155], v4 offset:8704
    v_mfma_f32_32x32x16_bf16 v[24:39], v[136:139], v[80:83], v[24:39]
    ds_read_b64_tr_b16 v[160:161], v5 offset:8192
    ds_read_b64_tr_b16 v[162:163], v5 offset:8704
    v_mfma_f32_32x32x16_bf16 v[40:55], v[144:147], v[72:75], v[40:55]
    ds_read_b64_tr_b16 v[156:157], v4 offset:10240
    ds_read_b64_tr_b16 v[158:159], v4 offset:10752
    v_mfma_f32_32x32x16_bf16 v[56:71], v[144:147], v[80:83], v[56:71]
    ds_read_b64_tr_b16 v[164:165], v5 offset:10240
    ds_read_b64_tr_b16 v[166:167], v5 offset:10752
    v_mfma_f32_32x32x16_bf16 v[8:23], v[140:143], v[76:79], v[8:23]
    s_add_u32 m0, s28, 24576
    s_nop 0
    buffer_load_dwordx4 v2, s[12:15], s23 offen lds
    s_add_u32 m0, m0, 0x400
    v_mfma_f32_32x32x16_bf16 v[24:39], v[140:143], v[84:87], v[24:39]
    buffer_load_dwordx4 v3, s[12:15], s23 offen lds
    s_add_u32 s23, s23, 131072
    buffer_load_dwordx4 v[120:123], v0, s[8:11], s22 offen offset:0
    v_mfma_f32_32x32x16_bf16 v[40:55], v[148:151], v[76:79], v[40:55]
    buffer_load_dwordx4 v[124:127], v0, s[8:11], s22 offen offset:512
    buffer_load_dwordx4 v[128:131], v1, s[8:11], s22 offen offset:0
    v_mfma_f32_32x32x16_bf16 v[56:71], v[148:151], v[84:87], v[56:71]
    buffer_load_dwordx4 v[132:135], v1, s[8:11], s22 offen offset:512
    s_add_u32 s22, s22, 2048
    s_waitcnt vmcnt(10)
    s_waitcnt lgkmcnt(0)
    s_barrier
    v_mfma_f32_32x32x16_bf16 v[8:23], v[152:155], v[88:91], v[8:23]
    ds_read_b64_tr_b16 v[136:137], v4 offset:16384
    ds_read_b64_tr_b16 v[138:139], v4 offset:16896
    v_mfma_f32_32x32x16_bf16 v[24:39], v[152:155], v[96:99], v[24:39]
    ds_read_b64_tr_b16 v[144:145], v5 offset:16384
    ds_read_b64_tr_b16 v[146:147], v5 offset:16896
    v_mfma_f32_32x32x16_bf16 v[40:55], v[160:163], v[88:91], v[40:55]
    ds_read_b64_tr_b16 v[140:141], v4 offset:18432
    ds_read_b64_tr_b16 v[142:143], v4 offset:18944
    v_mfma_f32_32x32x16_bf16 v[56:71], v[160:163], v[96:99], v[56:71]
    ds_read_b64_tr_b16 v[148:149], v5 offset:18432
    ds_read_b64_tr_b16 v[150:151], v5 offset:18944
    v_mfma_f32_32x32x16_bf16 v[8:23], v[156:159], v[92:95], v[8:23]
    s_add_u32 m0, s28, 0
    s_nop 0
    buffer_load_dwordx4 v2, s[12:15], s23 offen lds
    s_add_u32 m0, m0, 0x400
    v_mfma_f32_32x32x16_bf16 v[24:39], v[156:159], v[100:103], v[24:39]
    buffer_load_dwordx4 v3, s[12:15], s23 offen lds
    s_add_u32 s23, s23, 131072
    buffer_load_dwordx4 v[72:75], v0, s[8:11], s22 offen offset:0
    v_mfma_f32_32x32x16_bf16 v[40:55], v[164:167], v[92:95], v[40:55]
    buffer_load_dwordx4 v[76:79], v0, s[8:11], s22 offen offset:512
    buffer_load_dwordx4 v[80:83], v1, s[8:11], s22 offen offset:0
    v_mfma_f32_32x32x16_bf16 v[56:71], v[164:167], v[100:103], v[56:71]
    buffer_load_dwordx4 v[84:87], v1, s[8:11], s22 offen offset:512
    s_add_u32 s22, s22, 2048
    s_waitcnt vmcnt(10)
    s_waitcnt lgkmcnt(0)
    s_barrier
    v_mfma_f32_32x32x16_bf16 v[8:23], v[136:139], v[104:107], v[8:23]
    ds_read_b64_tr_b16 v[152:153], v4 offset:24576
    ds_read_b64_tr_b16 v[154:155], v4 offset:25088
    v_mfma_f32_32x32x16_bf16 v[24:39], v[136:139], v[112:115], v[24:39]
    ds_read_b64_tr_b16 v[160:161], v5 offset:24576
    ds_read_b64_tr_b16 v[162:163], v5 offset:25088
    v_mfma_f32_32x32x16_bf16 v[40:55], v[144:147], v[104:107], v[40:55]
    ds_read_b64_tr_b16 v[156:157], v4 offset:26624
    ds_read_b64_tr_b16 v[158:159], v4 offset:27136
    v_mfma_f32_32x32x16_bf16 v[56:71], v[144:147], v[112:115], v[56:71]
    ds_read_b64_tr_b16 v[164:165], v5 offset:26624
    ds_read_b64_tr_b16 v[166:167], v5 offset:27136
    v_mfma_f32_32x32x16_bf16 v[8:23], v[140:143], v[108:111], v[8:23]
    s_add_u32 m0, s28, 8192
    s_nop 0
    buffer_load_dwordx4 v2, s[12:15], s23 offen lds
    s_add_u32 m0, m0, 0x400
    v_mfma_f32_32x32x16_bf16 v[24:39], v[140:143], v[116:119], v[24:39]
    buffer_load_dwordx4 v3, s[12:15], s23 offen lds
    s_add_u32 s23, s23, 131072
    buffer_load_dwordx4 v[88:91], v0, s[8:11], s22 offen offset:0
    v_mfma_f32_32x32x16_bf16 v[40:55], v[148:151], v[108:111], v[40:55]
    buffer_load_dwordx4 v[92:95], v0, s[8:11], s22 offen offset:512
    buffer_load_dwordx4 v[96:99], v1, s[8:11], s22 offen offset:0
    v_mfma_f32_32x32x16_bf16 v[56:71], v[148:151], v[116:119], v[56:71]
    buffer_load_dwordx4 v[100:103], v1, s[8:11], s22 offen offset:512
    s_add_u32 s22, s22, 2048
    s_waitcnt vmcnt(10)
    s_waitcnt lgkmcnt(0)
    s_barrier
    v_mfma_f32_32x32x16_bf16 v[8:23], v[152:155], v[120:123], v[8:23]
    ds_read_b64_tr_b16 v[136:137], v4 offset:0
    ds_read_b64_tr_b16 v[138:139], v4 offset:512
    v_mfma_f32_32x32x16_bf16 v[24:39], v[152:155], v[128:131], v[24:39]
    ds_read_b64_tr_b16 v[144:145], v5 offset:0
    ds_read_b64_tr_b16 v[146:147], v5 offset:512
    v_mfma_f32_32x32x16_bf16 v[40:55], v[160:163], v[120:123], v[40:55]
    ds_read_b64_tr_b16 v[140:141], v4 offset:2048
    ds_read_b64_tr_b16 v[142:143], v4 offset:2560
    v_mfma_f32_32x32x16_bf16 v[56:71], v[160:163], v[128:131], v[56:71]
    ds_read_b64_tr_b16 v[148:149], v5 offset:2048
    ds_read_b64_tr_b16 v[150:151], v5 offset:2560
    v_mfma_f32_32x32x16_bf16 v[8:23], v[156:159], v[124:127], v[8:23]
    s_add_u32 m0, s28, 16384
    s_nop 0
    buffer_load_dwordx4 v2, s[12:15], s23 offen lds
    s_add_u32 m0, m0, 0x400
    v_mfma_f32_32x32x16_bf16 v[24:39], v[156:159], v[132:135], v[24:39]
    buffer_load_dwordx4 v3, s[12:15], s23 offen lds
    s_add_u32 s23, s23, 131072
    buffer_load_dwordx4 v[104:107], v0, s[8:11], s22 offen offset:0
    v_mfma_f32_32x32x16_bf16 v[40:55], v[164:167], v[124:127], v[40:55]
    buffer_load_dwordx4 v[108:111], v0, s[8:11], s22 offen offset:512
    buffer_load_dwordx4 v[112:115], v1, s[8:11], s22 offen offset:0
    v_mfma_f32_32x32x16_bf16 v[56:71], v[164:167], v[132:135], v[56:71]
    buffer_load_dwordx4 v[116:119], v1, s[8:11], s22 offen offset:512
    s_add_u32 s22, s22, 2048
    s_waitcnt vmcnt(10)
    s_waitcnt lgkmcnt(0)
    s_barrier
    v_mfma_f32_32x32x16_bf16 v[8:23], v[136:139], v[72:75], v[8:23]
    ds_read_b64_tr_b16 v[152:153], v4 offset:8192
    ds_read_b64_tr_b16 v[154:155], v4 offset:8704
    v_mfma_f32_32x32x16_bf16 v[24:39], v[136:139], v[80:83], v[24:39]
    ds_read_b64_tr_b16 v[160:161], v5 offset:8192
    ds_read_b64_tr_b16 v[162:163], v5 offset:8704
    v_mfma_f32_32x32x16_bf16 v[40:55], v[144:147], v[72:75], v[40:55]
    ds_read_b64_tr_b16 v[156:157], v4 offset:10240
    ds_read_b64_tr_b16 v[158:159], v4 offset:10752
    v_mfma_f32_32x32x16_bf16 v[56:71], v[144:147], v[80:83], v[56:71]
    ds_read_b64_tr_b16 v[164:165], v5 offset:10240
    ds_read_b64_tr_b16 v[166:167], v5 offset:10752
    v_mfma_f32_32x32x16_bf16 v[8:23], v[140:143], v[76:79], v[8:23]
    s_add_u32 m0, s28, 24576
    s_nop 0
    buffer_load_dwordx4 v2, s[12:15], s23 offen lds
    s_add_u32 m0, m0, 0x400
    v_mfma_f32_32x32x16_bf16 v[24:39], v[140:143], v[84:87], v[24:39]
    buffer_load_dwordx4 v3, s[12:15], s23 offen lds
    s_add_u32 s23, s23, 131072
    buffer_load_dwordx4 v[120:123], v0, s[8:11], s22 offen offset:0
    v_mfma_f32_32x32x16_bf16 v[40:55], v[148:151], v[76:79], v[40:55]
    buffer_load_dwordx4 v[124:127], v0, s[8:11], s22 offen offset:512
    buffer_load_dwordx4 v[128:131], v1, s[8:11], s22 offen offset:0
    v_mfma_f32_32x32x16_bf16 v[56:71], v[148:151], v[84:87], v[56:71]
    buffer_load_dwordx4 v[132:135], v1, s[8:11], s22 offen offset:512
    s_add_u32 s22, s22, 2048
    s_waitcnt vmcnt(10)
    s_waitcnt lgkmcnt(0)
    s_barrier
    v_mfma_f32_32x32x16_bf16 v[8:23], v[152:155], v[88:91], v[8:23]
    ds_read_b64_tr_b16 v[136:137], v4 offset:16384
    ds_read_b64_tr_b16 v[138:139], v4 offset:16896
    v_mfma_f32_32x32x16_bf16 v[24:39], v[152:155], v[96:99], v[24:39]
    ds_read_b64_tr_b16 v[144:145], v5 offset:16384
    ds_read_b64_tr_b16 v[146:147], v5 offset:16896
    v_mfma_f32_32x32x16_bf16 v[40:55], v[160:163], v[88:91], v[40:55]
    ds_read_b64_tr_b16 v[140:141], v4 offset:18432
    ds_read_b64_tr_b16 v[142:143], v4 offset:18944
    v_mfma_f32_32x32x16_bf16 v[56:71], v[160:163], v[96:99], v[56:71]
    ds_read_b64_tr_b16 v[148:149], v5 offset:18432
    ds_read_b64_tr_b16 v[150:151], v5 offset:18944
    v_mfma_f32_32x32x16_bf16 v[8:23], v[156:159], v[92:95], v[8:23]
    s_add_u32 m0, s28, 0
    s_nop 0
    buffer_load_dwordx4 v2, s[12:15], s23 offen lds
    s_add_u32 m0, m0, 0x400
    v_mfma_f32_32x32x16_bf16 v[24:39], v[156:159], v[100:103], v[24:39]
    buffer_load_dwordx4 v3, s[12:15], s23 offen lds
    s_add_u32 s23, s23, 131072
    buffer_load_dwordx4 v[72:75], v0, s[8:11], s22 offen offset:0
    v_mfma_f32_32x32x16_bf16 v[40:55], v[164:167], v[92:95], v[40:55]
    buffer_load_dwordx4 v[76:79], v0, s[8:11], s22 offen offset:512
    buffer_load_dwordx4 v[80:83], v1, s[8:11], s22 offen offset:0
    v_mfma_f32_32x32x16_bf16 v[56:71], v[164:167], v[100:103], v[56:71]
    buffer_load_dwordx4 v[84:87], v1, s[8:11], s22 offen offset:512
    s_add_u32 s22, s22, 2048
    s_waitcnt vmcnt(10)
    s_waitcnt lgkmcnt(0)
    s_barrier
    v_mfma_f32_32x32x16_bf16 v[8:23], v[136:139], v[104:107], v[8:23]
    ds_read_b64_tr_b16 v[152:153], v4 offset:24576
    ds_read_b64_tr_b16 v[154:155], v4 offset:25088
    v_mfma_f32_32x32x16_bf16 v[24:39], v[136:139], v[112:115], v[24:39]
    ds_read_b64_tr_b16 v[160:161], v5 offset:24576
    ds_read_b64_tr_b16 v[162:163], v5 offset:25088
    v_mfma_f32_32x32x16_bf16 v[40:55], v[144:147], v[104:107], v[40:55]
    ds_read_b64_tr_b16 v[156:157], v4 offset:26624
    ds_read_b64_tr_b16 v[158:159], v4 offset:27136
    v_mfma_f32_32x32x16_bf16 v[56:71], v[144:147], v[112:115], v[56:71]
    ds_read_b64_tr_b16 v[164:165], v5 offset:26624
    ds_read_b64_tr_b16 v[166:167], v5 offset:27136
    v_mfma_f32_32x32x16_bf16 v[8:23], v[140:143], v[108:111], v[8:23]
    s_add_u32 m0, s28, 8192
    s_nop 0
    buffer_load_dwordx4 v2, s[12:15], s23 offen lds
    s_add_u32 m0, m0, 0x400
    v_mfma_f32_32x32x16_bf16 v[24:39], v[140:143], v[116:119], v[24:39]
    buffer_load_dwordx4 v3, s[12:15], s23 offen lds
    s_add_u32 s23, s23, 131072
    buffer_load_dwordx4 v[88:91], v0, s[8:11], s22 offen offset:0
    v_mfma_f32_32x32x16_bf16 v[40:55], v[148:151], v[108:111], v[40:55]
    buffer_load_dwordx4 v[92:95], v0, s[8:11], s22 offen offset:512
    buffer_load_dwordx4 v[96:99], v1, s[8:11], s22 offen offset:0
    v_mfma_f32_32x32x16_bf16 v[56:71], v[148:151], v[116:119], v[56:71]
    buffer_load_dwordx4 v[100:103], v1, s[8:11], s22 offen offset:512
    s_add_u32 s22, s22, 2048
    s_waitcnt vmcnt(10)
    s_waitcnt lgkmcnt(0)
    s_barrier
    v_mfma_f32_32x32x16_bf16 v[8:23], v[152:155], v[120:123], v[8:23]
    ds_read_b64_tr_b16 v[136:137], v4 offset:0
    ds_read_b64_tr_b16 v[138:139], v4 offset:512
    v_mfma_f32_32x32x16_bf16 v[24:39], v[152:155], v[128:131], v[24:39]
    ds_read_b64_tr_b16 v[144:145], v5 offset:0
    ds_read_b64_tr_b16 v[146:147], v5 offset:512
    v_mfma_f32_32x32x16_bf16 v[40:55], v[160:163], v[120:123], v[40:55]
    ds_read_b64_tr_b16 v[140:141], v4 offset:2048
    ds_read_b64_tr_b16 v[142:143], v4 offset:2560
    v_mfma_f32_32x32x16_bf16 v[56:71], v[160:163], v[128:131], v[56:71]
    ds_read_b64_tr_b16 v[148:149], v5 offset:2048
    ds_read_b64_tr_b16 v[150:151], v5 offset:2560
    v_mfma_f32_32x32x16_bf16 v[8:23], v[156:159], v[124:127], v[8:23]
    s_add_u32 m0, s28, 16384
    s_nop 0
    buffer_load_dwordx4 v2, s[12:15], s23 offen lds
    s_add_u32 m0, m0, 0x400
    v_mfma_f32_32x32x16_bf16 v[24:39], v[156:159], v[132:135], v[24:39]
    buffer_load_dwordx4 v3, s[12:15], s23 offen lds
    s_add_u32 s23, s23, 131072
    buffer_load_dwordx4 v[104:107], v0, s[8:11], s22 offen offset:0
    v_mfma_f32_32x32x16_bf16 v[40:55], v[164:167], v[124:127], v[40:55]
    buffer_load_dwordx4 v[108:111], v0, s[8:11], s22 offen offset:512
    buffer_load_dwordx4 v[112:115], v1, s[8:11], s22 offen offset:0
    v_mfma_f32_32x32x16_bf16 v[56:71], v[164:167], v[132:135], v[56:71]
    buffer_load_dwordx4 v[116:119], v1, s[8:11], s22 offen offset:512
    s_add_u32 s22, s22, 2048
    s_waitcnt vmcnt(10)
    s_waitcnt lgkmcnt(0)
    s_barrier
    v_mfma_f32_32x32x16_bf16 v[8:23], v[136:139], v[72:75], v[8:23]
    ds_read_b64_tr_b16 v[152:153], v4 offset:8192
    ds_read_b64_tr_b16 v[154:155], v4 offset:8704
    v_mfma_f32_32x32x16_bf16 v[24:39], v[136:139], v[80:83], v[24:39]
    ds_read_b64_tr_b16 v[160:161], v5 offset:8192
    ds_read_b64_tr_b16 v[162:163], v5 offset:8704
    v_mfma_f32_32x32x16_bf16 v[40:55], v[144:147], v[72:75], v[40:55]
    ds_read_b64_tr_b16 v[156:157], v4 offset:10240
    ds_read_b64_tr_b16 v[158:159], v4 offset:10752
    v_mfma_f32_32x32x16_bf16 v[56:71], v[144:147], v[80:83], v[56:71]
    ds_read_b64_tr_b16 v[164:165], v5 offset:10240
    ds_read_b64_tr_b16 v[166:167], v5 offset:10752
    v_mfma_f32_32x32x16_bf16 v[8:23], v[140:143], v[76:79], v[8:23]
    s_add_u32 m0, s28, 24576
    s_nop 0
    buffer_load_dwordx4 v2, s[12:15], s23 offen lds
    s_add_u32 m0, m0, 0x400
    v_mfma_f32_32x32x16_bf16 v[24:39], v[140:143], v[84:87], v[24:39]
    buffer_load_dwordx4 v3, s[12:15], s23 offen lds
    s_add_u32 s23, s23, 131072
    buffer_load_dwordx4 v[120:123], v0, s[8:11], s22 offen offset:0
    v_mfma_f32_32x32x16_bf16 v[40:55], v[148:151], v[76:79], v[40:55]
    buffer_load_dwordx4 v[124:127], v0, s[8:11], s22 offen offset:512
    buffer_load_dwordx4 v[128:131], v1, s[8:11], s22 offen offset:0
    v_mfma_f32_32x32x16_bf16 v[56:71], v[148:151], v[84:87], v[56:71]
    buffer_load_dwordx4 v[132:135], v1, s[8:11], s22 offen offset:512
    s_add_u32 s22, s22, 2048
    s_waitcnt vmcnt(10)
    s_waitcnt lgkmcnt(0)
    s_barrier
    v_mfma_f32_32x32x16_bf16 v[8:23], v[152:155], v[88:91], v[8:23]
    ds_read_b64_tr_b16 v[136:137], v4 offset:16384
    v_mfma_f32_32x32x16_bf16 v[24:39], v[152:155], v[96:99], v[24:39]
    ds_read_b64_tr_b16 v[138:139], v4 offset:16896
    v_mfma_f32_32x32x16_bf16 v[40:55], v[160:163], v[88:91], v[40:55]
    ds_read_b64_tr_b16 v[144:145], v5 offset:16384
    v_mfma_f32_32x32x16_bf16 v[56:71], v[160:163], v[96:99], v[56:71]
    ds_read_b64_tr_b16 v[146:147], v5 offset:16896
    v_mfma_f32_32x32x16_bf16 v[8:23], v[156:159], v[92:95], v[8:23]
    ds_read_b64_tr_b16 v[140:141], v4 offset:18432
    v_mfma_f32_32x32x16_bf16 v[24:39], v[156:159], v[100:103], v[24:39]
    ds_read_b64_tr_b16 v[142:143], v4 offset:18944
    v_mfma_f32_32x32x16_bf16 v[40:55], v[164:167], v[92:95], v[40:55]
    ds_read_b64_tr_b16 v[148:149], v5 offset:18432
    v_mfma_f32_32x32x16_bf16 v[56:71], v[164:167], v[100:103], v[56:71]
    ds_read_b64_tr_b16 v[150:151], v5 offset:18944
    s_waitcnt vmcnt(4)
    s_waitcnt lgkmcnt(0)
    s_barrier
    v_mfma_f32_32x32x16_bf16 v[8:23], v[136:139], v[104:107], v[8:23]
    ds_read_b64_tr_b16 v[152:153], v4 offset:24576
    v_mfma_f32_32x32x16_bf16 v[24:39], v[136:139], v[112:115], v[24:39]
    ds_read_b64_tr_b16 v[154:155], v4 offset:25088
    v_mfma_f32_32x32x16_bf16 v[40:55], v[144:147], v[104:107], v[40:55]
    ds_read_b64_tr_b16 v[160:161], v5 offset:24576
    v_mfma_f32_32x32x16_bf16 v[56:71], v[144:147], v[112:115], v[56:71]
    ds_read_b64_tr_b16 v[162:163], v5 offset:25088
    v_mfma_f32_32x32x16_bf16 v[8:23], v[140:143], v[108:111], v[8:23]
    ds_read_b64_tr_b16 v[156:157], v4 offset:26624
    v_mfma_f32_32x32x16_bf16 v[24:39], v[140:143], v[116:119], v[24:39]
    ds_read_b64_tr_b16 v[158:159], v4 offset:27136
    v_mfma_f32_32x32x16_bf16 v[40:55], v[148:151], v[108:111], v[40:55]
    ds_read_b64_tr_b16 v[164:165], v5 offset:26624
    v_mfma_f32_32x32x16_bf16 v[56:71], v[148:151], v[116:119], v[56:71]
    ds_read_b64_tr_b16 v[166:167], v5 offset:27136
    s_waitcnt vmcnt(0)
    s_waitcnt lgkmcnt(0)
    v_mfma_f32_32x32x16_bf16 v[8:23], v[152:155], v[120:123], v[8:23]
    v_mfma_f32_32x32x16_bf16 v[24:39], v[152:155], v[128:131], v[24:39]
    v_mfma_f32_32x32x16_bf16 v[40:55], v[160:163], v[120:123], v[40:55]
    v_mfma_f32_32x32x16_bf16 v[56:71], v[160:163], v[128:131], v[56:71]
    v_mfma_f32_32x32x16_bf16 v[8:23], v[156:159], v[124:127], v[8:23]
    v_mfma_f32_32x32x16_bf16 v[24:39], v[156:159], v[132:135], v[24:39]
    v_mfma_f32_32x32x16_bf16 v[40:55], v[164:167], v[124:127], v[40:55]
    v_mfma_f32_32x32x16_bf16 v[56:71], v[164:167], v[132:135], v[56:71]
    s_setprio 3
    s_barrier
    v_mbcnt_lo_u32_b32 v6, -1, 0
    v_mbcnt_hi_u32_b32 v6, -1, v6
    v_and_b32 v6, 31, v6
    v_lshlrev_b32 v6, 2, v6
    s_lshl_b32 s51, s42, 7
    s_add_u32 s51, s51, 62914560
    v_add_u32 v6, s51, v6
    s_mov_b32 s52, 0x40000
    s_mov_b32 s34, 0
    s_mov_b32 s35, 0x55555555
    s_lshl_b32 s35, s35, s49
    s_mov_b32 s12, s30
    s_mov_b32 s13, s31
    s_lshl_b32 s51, s43, 7
    s_sub_u32 s14, 2097152, s51
    s_mul_i32 s28, s20, 12288
    s_lshl_b32 s51, s49, 12
    s_sub_u32 s51, s28, s51
    v_add_u32 v4, s51, v4
    v_add_u32 v5, s51, v5
    s_lshl_b32 s51, s20, 15
    v_subrev_u32 v2, s51, v2
    v_subrev_u32 v3, s51, v3
    s_and_b32 s51, s34, s35
    s_cbranch_scc1 L_dn_go0
L_dn_poll0:
    global_load_dword v7, v6, s[40:41] sc1
    s_waitcnt vmcnt(0)
    v_cmp_ne_u32 vcc, 0, v7
    s_nop 3
    s_mov_b32 s34, vcc_lo
    s_sub_u32 s52, s52, 1
    s_cmp_eq_u32 s52, 0
    s_cselect_b32 s34, -1, s34
    s_and_b32 s51, s34, s35
    s_cbranch_scc1 L_dn_go0
    s_sleep 6
    s_branch L_dn_poll0
L_dn_go0:
    s_ff1_i32_b32 s51, s51
    s_bitset0_b32 s35, s51
    s_lshl_b32 s22, s51, 10
    s_lshl_b32 s23, s51, 16
    s_add_u32 m0, s28, 0
    s_add_u32 s53, s23, 32768
    buffer_load_dwordx4 v[72:75], v0, s[8:11], s22 offen offset:0 sc1
    buffer_load_dwordx4 v[76:79], v0, s[8:11], s22 offen offset:512 sc1
    buffer_load_dwordx4 v[80:83], v1, s[8:11], s22 offen offset:0 sc1
    buffer_load_dwordx4 v[84:87], v1, s[8:11], s22 offen offset:512 sc1
    buffer_load_dwordx4 v2, s[12:15], s23 offen lds
    s_add_u32 m0, m0, 0x400
    s_nop 0
    buffer_load_dwordx4 v3, s[12:15], s23 offen lds
    s_add_u32 m0, m0, 0x400
    s_nop 0
    buffer_load_dwordx4 v2, s[12:15], s53 offen lds
    s_add_u32 m0, m0, 0x400
    s_nop 0
    buffer_load_dwordx4 v3, s[12:15], s53 offen lds
    s_add_u32 m0, m0, 0x400
    s_nop 0
    s_and_b32 s51, s34, s35
    s_cbranch_scc1 L_dn_go1
L_dn_poll1:
    global_load_dword v7, v6, s[40:41] sc1
    s_waitcnt vmcnt(0)
    v_cmp_ne_u32 vcc, 0, v7
    s_nop 3
    s_mov_b32 s34, vcc_lo
    s_sub_u32 s52, s52, 1
    s_cmp_eq_u32 s52, 0
    s_cselect_b32 s34, -1, s34
    s_and_b32 s51, s34, s35
    s_cbranch_scc1 L_dn_go1
    s_sleep 6
    s_branch L_dn_poll1
L_dn_go1:
    s_ff1_i32_b32 s51, s51
    s_bitset0_b32 s35, s51
    s_lshl_b32 s22, s51, 10
    s_lshl_b32 s23, s51, 16
    s_add_u32 m0, s28, 4096
    s_add_u32 s53, s23, 32768
    buffer_load_dwordx4 v[88:91], v0, s[8:11], s22 offen offset:0 sc1
    buffer_load_dwordx4 v[92:95], v0, s[8:11], s22 offen offset:512 sc1
    buffer_load_dwordx4 v[96:99], v1, s[8:11], s22 offen offset:0 sc1
    buffer_load_dwordx4 v[100:103], v1, s[8:11], s22 offen offset:512 sc1
    buffer_load_dwordx4 v2, s[12:15], s23 offen lds
    s_add_u32 m0, m0, 0x400
    s_nop 0
    buffer_load_dwordx4 v3, s[12:15], s23 offen lds
    s_add_u32 m0, m0, 0x400
    s_nop 0
    buffer_load_dwordx4 v2, s[12:15], s53 offen lds
    s_add_u32 m0, m0, 0x400
    s_nop 0
    buffer_load_dwordx4 v3, s[12:15], s53 offen lds
    s_add_u32 m0, m0, 0x400
    s_nop 0
    s_waitcnt vmcnt(8)
    ds_read_b64_tr_b16 v[136:137], v4 offset:0
    ds_read_b64_tr_b16 v[138:139], v4 offset:512
    ds_read_b64_tr_b16 v[144:145], v5 offset:0
    ds_read_b64_tr_b16 v[146:147], v5 offset:512
    ds_read_b64_tr_b16 v[140:141], v4 offset:2048
    ds_read_b64_tr_b16 v[142:143], v4 offset:2560
    ds_read_b64_tr_b16 v[148:149], v5 offset:2048
    ds_read_b64_tr_b16 v[150:151], v5 offset:2560
    s_and_b32 s51, s34, s35
    s_cbranch_scc1 L_dn_go2
L_dn_poll2:
    global_load_dword v7, v6, s[40:41] sc1
    s_waitcnt vmcnt(0)
    v_cmp_ne_u32 vcc, 0, v7
    s_nop 3
    s_mov_b32 s34, vcc_lo
    s_sub_u32 s52, s52, 1
    s_cmp_eq_u32 s52, 0
    s_cselect_b32 s34, -1, s34
    s_and_b32 s51, s34, s35
    s_cbranch_scc1 L_dn_go2
    s_sleep 6
    s_branch L_dn_poll2
L_dn_go2:
    s_ff1_i32_b32 s51, s51
    s_bitset0_b32 s35, s51
    s_lshl_b32 s22, s51, 10
    s_lshl_b32 s23, s51, 16
    s_add_u32 m0, s28, 8192
    s_add_u32 s53, s23, 32768
    buffer_load_dwordx4 v[104:107], v0, s[8:11], s22 offen offset:0 sc1
    buffer_load_dwordx4 v[108:111], v0, s[8:11], s22 offen offset:512 sc1
    buffer_load_dwordx4 v[112:115], v1, s[8:11], s22 offen offset:0 sc1
    buffer_load_dwordx4 v[116:119], v1, s[8:11], s22 offen offset:512 sc1
    buffer_load_dwordx4 v2, s[12:15], s23 offen lds
    s_add_u32 m0, m0, 0x400
    s_nop 0
    buffer_load_dwordx4 v3, s[12:15], s23 offen lds
    s_add_u32 m0, m0, 0x400
    s_nop 0
    buffer_load_dwordx4 v2, s[12:15], s53 offen lds
    s_add_u32 m0, m0, 0x400
    s_nop 0
    buffer_load_dwordx4 v3, s[12:15], s53 offen lds
    s_add_u32 m0, m0, 0x400
    s_nop 0
    s_waitcnt lgkmcnt(0)
    v_mfma_f32_32x32x16_bf16 v[8:23], v[136:139], v[72:75], v[8:23]
    v_mfma_f32_32x32x16_bf16 v[24:39], v[136:139], v[80:83], v[24:39]
    v_mfma_f32_32x32x16_bf16 v[40:55], v[144:147], v[72:75], v[40:55]
    v_mfma_f32_32x32x16_bf16 v[56:71], v[144:147], v[80:83], v[56:71]
    v_mfma_f32_32x32x16_bf16 v[8:23], v[140:143], v[76:79], v[8:23]
    v_mfma_f32_32x32x16_bf16 v[24:39], v[140:143], v[84:87], v[24:39]
    v_mfma_f32_32x32x16_bf16 v[40:55], v[148:151], v[76:79], v[40:55]
    v_mfma_f32_32x32x16_bf16 v[56:71], v[148:151], v[84:87], v[56:71]
    s_waitcnt vmcnt(8)
    ds_read_b64_tr_b16 v[152:153], v4 offset:4096
    ds_read_b64_tr_b16 v[154:155], v4 offset:4608
    ds_read_b64_tr_b16 v[160:161], v5 offset:4096
    ds_read_b64_tr_b16 v[162:163], v5 offset:4608
    ds_read_b64_tr_b16 v[156:157], v4 offset:6144
    ds_read_b64_tr_b16 v[158:159], v4 offset:6656
    ds_read_b64_tr_b16 v[164:165], v5 offset:6144
    ds_read_b64_tr_b16 v[166:167], v5 offset:6656
    s_and_b32 s51, s34, s35
    s_cbranch_scc1 L_dn_go3
L_dn_poll3:
    global_load_dword v7, v6, s[40:41] sc1
    s_waitcnt vmcnt(0)
    v_cmp_ne_u32 vcc, 0, v7
    s_nop 3
    s_mov_b32 s34, vcc_lo
    s_sub_u32 s52, s52, 1
    s_cmp_eq_u32 s52, 0
    s_cselect_b32 s34, -1, s34
    s_and_b32 s51, s34, s35
    s_cbranch_scc1 L_dn_go3
    s_sleep 6
    s_branch L_dn_poll3
L_dn_go3:
    s_ff1_i32_b32 s51, s51
    s_bitset0_b32 s35, s51
    s_lshl_b32 s22, s51, 10
    s_lshl_b32 s23, s51, 16
    s_add_u32 m0, s28, 0
    s_add_u32 s53, s23, 32768
    buffer_load_dwordx4 v[120:123], v0, s[8:11], s22 offen offset:0 sc1
    buffer_load_dwordx4 v[124:127], v0, s[8:11], s22 offen offset:512 sc1
    buffer_load_dwordx4 v[128:131], v1, s[8:11], s22 offen offset:0 sc1
    buffer_load_dwordx4 v[132:135], v1, s[8:11], s22 offen offset:512 sc1
    buffer_load_dwordx4 v2, s[12:15], s23 offen lds
    s_add_u32 m0, m0, 0x400
    s_nop 0
    buffer_load_dwordx4 v3, s[12:15], s23 offen lds
    s_add_u32 m0, m0, 0x400
    s_nop 0
    buffer_load_dwordx4 v2, s[12:15], s53 offen lds
    s_add_u32 m0, m0, 0x400
    s_nop 0
    buffer_load_dwordx4 v3, s[12:15], s53 offen lds
    s_add_u32 m0, m0, 0x400
    s_nop 0
    s_waitcnt lgkmcnt(0)
    v_mfma_f32_32x32x16_bf16 v[8:23], v[152:155], v[88:91], v[8:23]
    v_mfma_f32_32x32x16_bf16 v[24:39], v[152:155], v[96:99], v[24:39]
    v_mfma_f32_32x32x16_bf16 v[40:55], v[160:163], v[88:91], v[40:55]
    v_mfma_f32_32x32x16_bf16 v[56:71], v[160:163], v[96:99], v[56:71]
    v_mfma_f32_32x32x16_bf16 v[8:23], v[156:159], v[92:95], v[8:23]
    v_mfma_f32_32x32x16_bf16 v[24:39], v[156:159], v[100:103], v[24:39]
    v_mfma_f32_32x32x16_bf16 v[40:55], v[164:167], v[92:95], v[40:55]
    v_mfma_f32_32x32x16_bf16 v[56:71], v[164:167], v[100:103], v[56:71]
    s_waitcnt vmcnt(8)
    ds_read_b64_tr_b16 v[136:137], v4 offset:8192
    ds_read_b64_tr_b16 v[138:139], v4 offset:8704
    ds_read_b64_tr_b16 v[144:145], v5 offset:8192
    ds_read_b64_tr_b16 v[146:147], v5 offset:8704
    ds_read_b64_tr_b16 v[140:141], v4 offset:10240
    ds_read_b64_tr_b16 v[142:143], v4 offset:10752
    ds_read_b64_tr_b16 v[148:149], v5 offset:10240
    ds_read_b64_tr_b16 v[150:151], v5 offset:10752
    s_and_b32 s51, s34, s35
    s_cbranch_scc1 L_dn_go4
L_dn_poll4:
    global_load_dword v7, v6, s[40:41] sc1
    s_waitcnt vmcnt(0)
    v_cmp_ne_u32 vcc, 0, v7
    s_nop 3
    s_mov_b32 s34, vcc_lo
    s_sub_u32 s52, s52, 1
    s_cmp_eq_u32 s52, 0
    s_cselect_b32 s34, -1, s34
    s_and_b32 s51, s34, s35
    s_cbranch_scc1 L_dn_go4
    s_sleep 6
    s_branch L_dn_poll4
L_dn_go4:
    s_ff1_i32_b32 s51, s51
    s_bitset0_b32 s35, s51
    s_lshl_b32 s22, s51, 10
    s_lshl_b32 s23, s51, 16
    s_add_u32 m0, s28, 4096
    s_add_u32 s53, s23, 32768
    buffer_load_dwordx4 v[72:75], v0, s[8:11], s22 offen offset:0 sc1
    buffer_load_dwordx4 v[76:79], v0, s[8:11], s22 offen offset:512 sc1
    buffer_load_dwordx4 v[80:83], v1, s[8:11], s22 offen offset:0 sc1
    buffer_load_dwordx4 v[84:87], v1, s[8:11], s22 offen offset:512 sc1
    buffer_load_dwordx4 v2, s[12:15], s23 offen lds
    s_add_u32 m0, m0, 0x400
    s_nop 0
    buffer_load_dwordx4 v3, s[12:15], s23 offen lds
    s_add_u32 m0, m0, 0x400
    s_nop 0
    buffer_load_dwordx4 v2, s[12:15], s53 offen lds
    s_add_u32 m0, m0, 0x400
    s_nop 0
    buffer_load_dwordx4 v3, s[12:15], s53 offen lds
    s_add_u32 m0, m0, 0x400
    s_nop 0
    s_waitcnt lgkmcnt(0)
    v_mfma_f32_32x32x16_bf16 v[8:23], v[136:139], v[104:107], v[8:23]
    v_mfma_f32_32x32x16_bf16 v[24:39], v[136:139], v[112:115], v[24:39]
    v_mfma_f32_32x32x16_bf16 v[40:55], v[144:147], v[104:107], v[40:55]
    v_mfma_f32_32x32x16_bf16 v[56:71], v[144:147], v[112:115], v[56:71]
    v_mfma_f32_32x32x16_bf16 v[8:23], v[140:143], v[108:111], v[8:23]
    v_mfma_f32_32x32x16_bf16 v[24:39], v[140:143], v[116:119], v[24:39]
    v_mfma_f32_32x32x16_bf16 v[40:55], v[148:151], v[108:111], v[40:55]
    v_mfma_f32_32x32x16_bf16 v[56:71], v[148:151], v[116:119], v[56:71]
    s_waitcnt vmcnt(8)
    ds_read_b64_tr_b16 v[152:153], v4 offset:0
    ds_read_b64_tr_b16 v[154:155], v4 offset:512
    ds_read_b64_tr_b16 v[160:161], v5 offset:0
    ds_read_b64_tr_b16 v[162:163], v5 offset:512
    ds_read_b64_tr_b16 v[156:157], v4 offset:2048
    ds_read_b64_tr_b16 v[158:159], v4 offset:2560
    ds_read_b64_tr_b16 v[164:165], v5 offset:2048
    ds_read_b64_tr_b16 v[166:167], v5 offset:2560
    s_and_b32 s51, s34, s35
    s_cbranch_scc1 L_dn_go5
L_dn_poll5:
    global_load_dword v7, v6, s[40:41] sc1
    s_waitcnt vmcnt(0)
    v_cmp_ne_u32 vcc, 0, v7
    s_nop 3
    s_mov_b32 s34, vcc_lo
    s_sub_u32 s52, s52, 1
    s_cmp_eq_u32 s52, 0
    s_cselect_b32 s34, -1, s34
    s_and_b32 s51, s34, s35
    s_cbranch_scc1 L_dn_go5
    s_sleep 6
    s_branch L_dn_poll5
L_dn_go5:
    s_ff1_i32_b32 s51, s51
    s_bitset0_b32 s35, s51
    s_lshl_b32 s22, s51, 10
    s_lshl_b32 s23, s51, 16
    s_add_u32 m0, s28, 8192
    s_add_u32 s53, s23, 32768
    buffer_load_dwordx4 v[88:91], v0, s[8:11], s22 offen offset:0 sc1
    buffer_load_dwordx4 v[92:95], v0, s[8:11], s22 offen offset:512 sc1
    buffer_load_dwordx4 v[96:99], v1, s[8:11], s22 offen offset:0 sc1
    buffer_load_dwordx4 v[100:103], v1, s[8:11], s22 offen offset:512 sc1
    buffer_load_dwordx4 v2, s[12:15], s23 offen lds
    s_add_u32 m0, m0, 0x400
    s_nop 0
    buffer_load_dwordx4 v3, s[12:15], s23 offen lds
    s_add_u32 m0, m0, 0x400
    s_nop 0
    buffer_load_dwordx4 v2, s[12:15], s53 offen lds
    s_add_u32 m0, m0, 0x400
    s_nop 0
    buffer_load_dwordx4 v3, s[12:15], s53 offen lds
    s_add_u32 m0, m0, 0x400
    s_nop 0
    s_waitcnt lgkmcnt(0)
    v_mfma_f32_32x32x16_bf16 v[8:23], v[152:155], v[120:123], v[8:23]
    v_mfma_f32_32x32x16_bf16 v[24:39], v[152:155], v[128:131], v[24:39]
    v_mfma_f32_32x32x16_bf16 v[40:55], v[160:163], v[120:123], v[40:55]
    v_mfma_f32_32x32x16_bf16 v[56:71], v[160:163], v[128:131], v[56:71]
    v_mfma_f32_32x32x16_bf16 v[8:23], v[156:159], v[124:127], v[8:23]
    v_mfma_f32_32x32x16_bf16 v[24:39], v[156:159], v[132:135], v[24:39]
    v_mfma_f32_32x32x16_bf16 v[40:55], v[164:167], v[124:127], v[40:55]
    v_mfma_f32_32x32x16_bf16 v[56:71], v[164:167], v[132:135], v[56:71]
    s_waitcnt vmcnt(8)
    ds_read_b64_tr_b16 v[136:137], v4 offset:4096
    ds_read_b64_tr_b16 v[138:139], v4 offset:4608
    ds_read_b64_tr_b16 v[144:145], v5 offset:4096
    ds_read_b64_tr_b16 v[146:147], v5 offset:4608
    ds_read_b64_tr_b16 v[140:141], v4 offset:6144
    ds_read_b64_tr_b16 v[142:143], v4 offset:6656
    ds_read_b64_tr_b16 v[148:149], v5 offset:6144
    ds_read_b64_tr_b16 v[150:151], v5 offset:6656
    s_and_b32 s51, s34, s35
    s_cbranch_scc1 L_dn_go6
L_dn_poll6:
    global_load_dword v7, v6, s[40:41] sc1
    s_waitcnt vmcnt(0)
    v_cmp_ne_u32 vcc, 0, v7
    s_nop 3
    s_mov_b32 s34, vcc_lo
    s_sub_u32 s52, s52, 1
    s_cmp_eq_u32 s52, 0
    s_cselect_b32 s34, -1, s34
    s_and_b32 s51, s34, s35
    s_cbranch_scc1 L_dn_go6
    s_sleep 6
    s_branch L_dn_poll6
L_dn_go6:
    s_ff1_i32_b32 s51, s51
    s_bitset0_b32 s35, s51
    s_lshl_b32 s22, s51, 10
    s_lshl_b32 s23, s51, 16
    s_add_u32 m0, s28, 0
    s_add_u32 s53, s23, 32768
    buffer_load_dwordx4 v[104:107], v0, s[8:11], s22 offen offset:0 sc1
    buffer_load_dwordx4 v[108:111], v0, s[8:11], s22 offen offset:512 sc1
    buffer_load_dwordx4 v[112:115], v1, s[8:11], s22 offen offset:0 sc1
    buffer_load_dwordx4 v[116:119], v1, s[8:11], s22 offen offset:512 sc1
    buffer_load_dwordx4 v2, s[12:15], s23 offen lds
    s_add_u32 m0, m0, 0x400
    s_nop 0
    buffer_load_dwordx4 v3, s[12:15], s23 offen lds
    s_add_u32 m0, m0, 0x400
    s_nop 0
    buffer_load_dwordx4 v2, s[12:15], s53 offen lds
    s_add_u32 m0, m0, 0x400
    s_nop 0
    buffer_load_dwordx4 v3, s[12:15], s53 offen lds
    s_add_u32 m0, m0, 0x400
    s_nop 0
    s_waitcnt lgkmcnt(0)
    v_mfma_f32_32x32x16_bf16 v[8:23], v[136:139], v[72:75], v[8:23]
    v_mfma_f32_32x32x16_bf16 v[24:39], v[136:139], v[80:83], v[24:39]
    v_mfma_f32_32x32x16_bf16 v[40:55], v[144:147], v[72:75], v[40:55]
    v_mfma_f32_32x32x16_bf16 v[56:71], v[144:147], v[80:83], v[56:71]
    v_mfma_f32_32x32x16_bf16 v[8:23], v[140:143], v[76:79], v[8:23]
    v_mfma_f32_32x32x16_bf16 v[24:39], v[140:143], v[84:87], v[24:39]
    v_mfma_f32_32x32x16_bf16 v[40:55], v[148:151], v[76:79], v[40:55]
    v_mfma_f32_32x32x16_bf16 v[56:71], v[148:151], v[84:87], v[56:71]
    s_waitcnt vmcnt(8)
    ds_read_b64_tr_b16 v[152:153], v4 offset:8192
    ds_read_b64_tr_b16 v[154:155], v4 offset:8704
    ds_read_b64_tr_b16 v[160:161], v5 offset:8192
    ds_read_b64_tr_b16 v[162:163], v5 offset:8704
    ds_read_b64_tr_b16 v[156:157], v4 offset:10240
    ds_read_b64_tr_b16 v[158:159], v4 offset:10752
    ds_read_b64_tr_b16 v[164:165], v5 offset:10240
    ds_read_b64_tr_b16 v[166:167], v5 offset:10752
    s_and_b32 s51, s34, s35
    s_cbranch_scc1 L_dn_go7
L_dn_poll7:
    global_load_dword v7, v6, s[40:41] sc1
    s_waitcnt vmcnt(0)
    v_cmp_ne_u32 vcc, 0, v7
    s_nop 3
    s_mov_b32 s34, vcc_lo
    s_sub_u32 s52, s52, 1
    s_cmp_eq_u32 s52, 0
    s_cselect_b32 s34, -1, s34
    s_and_b32 s51, s34, s35
    s_cbranch_scc1 L_dn_go7
    s_sleep 6
    s_branch L_dn_poll7
L_dn_go7:
    s_ff1_i32_b32 s51, s51
    s_bitset0_b32 s35, s51
    s_lshl_b32 s22, s51, 10
    s_lshl_b32 s23, s51, 16
    s_add_u32 m0, s28, 4096
    s_add_u32 s53, s23, 32768
    buffer_load_dwordx4 v[120:123], v0, s[8:11], s22 offen offset:0 sc1
    buffer_load_dwordx4 v[124:127], v0, s[8:11], s22 offen offset:512 sc1
    buffer_load_dwordx4 v[128:131], v1, s[8:11], s22 offen offset:0 sc1
    buffer_load_dwordx4 v[132:135], v1, s[8:11], s22 offen offset:512 sc1
    buffer_load_dwordx4 v2, s[12:15], s23 offen lds
    s_add_u32 m0, m0, 0x400
    s_nop 0
    buffer_load_dwordx4 v3, s[12:15], s23 offen lds
    s_add_u32 m0, m0, 0x400
    s_nop 0
    buffer_load_dwordx4 v2, s[12:15], s53 offen lds
    s_add_u32 m0, m0, 0x400
    s_nop 0
    buffer_load_dwordx4 v3, s[12:15], s53 offen lds
    s_add_u32 m0, m0, 0x400
    s_nop 0
    s_waitcnt lgkmcnt(0)
    v_mfma_f32_32x32x16_bf16 v[8:23], v[152:155], v[88:91], v[8:23]
    v_mfma_f32_32x32x16_bf16 v[24:39], v[152:155], v[96:99], v[24:39]
    v_mfma_f32_32x32x16_bf16 v[40:55], v[160:163], v[88:91], v[40:55]
    v_mfma_f32_32x32x16_bf16 v[56:71], v[160:163], v[96:99], v[56:71]
    v_mfma_f32_32x32x16_bf16 v[8:23], v[156:159], v[92:95], v[8:23]
    v_mfma_f32_32x32x16_bf16 v[24:39], v[156:159], v[100:103], v[24:39]
    v_mfma_f32_32x32x16_bf16 v[40:55], v[164:167], v[92:95], v[40:55]
    v_mfma_f32_32x32x16_bf16 v[56:71], v[164:167], v[100:103], v[56:71]
    s_waitcnt vmcnt(8)
    ds_read_b64_tr_b16 v[136:137], v4 offset:0
    ds_read_b64_tr_b16 v[138:139], v4 offset:512
    ds_read_b64_tr_b16 v[144:145], v5 offset:0
    ds_read_b64_tr_b16 v[146:147], v5 offset:512
    ds_read_b64_tr_b16 v[140:141], v4 offset:2048
    ds_read_b64_tr_b16 v[142:143], v4 offset:2560
    ds_read_b64_tr_b16 v[148:149], v5 offset:2048
    ds_read_b64_tr_b16 v[150:151], v5 offset:2560
    s_and_b32 s51, s34, s35
    s_cbranch_scc1 L_dn_go8
L_dn_poll8:
    global_load_dword v7, v6, s[40:41] sc1
    s_waitcnt vmcnt(0)
    v_cmp_ne_u32 vcc, 0, v7
    s_nop 3
    s_mov_b32 s34, vcc_lo
    s_sub_u32 s52, s52, 1
    s_cmp_eq_u32 s52, 0
    s_cselect_b32 s34, -1, s34
    s_and_b32 s51, s34, s35
    s_cbranch_scc1 L_dn_go8
    s_sleep 6
    s_branch L_dn_poll8
L_dn_go8:
    s_ff1_i32_b32 s51, s51
    s_bitset0_b32 s35, s51
    s_lshl_b32 s22, s51, 10
    s_lshl_b32 s23, s51, 16
    s_add_u32 m0, s28, 8192
    s_add_u32 s53, s23, 32768
    buffer_load_dwordx4 v[72:75], v0, s[8:11], s22 offen offset:0 sc1
    buffer_load_dwordx4 v[76:79], v0, s[8:11], s22 offen offset:512 sc1
    buffer_load_dwordx4 v[80:83], v1, s[8:11], s22 offen offset:0 sc1
    buffer_load_dwordx4 v[84:87], v1, s[8:11], s22 offen offset:512 sc1
    buffer_load_dwordx4 v2, s[12:15], s23 offen lds
    s_add_u32 m0, m0, 0x400
    s_nop 0
    buffer_load_dwordx4 v3, s[12:15], s23 offen lds
    s_add_u32 m0, m0, 0x400
    s_nop 0
    buffer_load_dwordx4 v2, s[12:15], s53 offen lds
    s_add_u32 m0, m0, 0x400
    s_nop 0
    buffer_load_dwordx4 v3, s[12:15], s53 offen lds
    s_add_u32 m0, m0, 0x400
    s_nop 0
    s_waitcnt lgkmcnt(0)
    v_mfma_f32_32x32x16_bf16 v[8:23], v[136:139], v[104:107], v[8:23]
    v_mfma_f32_32x32x16_bf16 v[24:39], v[136:139], v[112:115], v[24:39]
    v_mfma_f32_32x32x16_bf16 v[40:55], v[144:147], v[104:107], v[40:55]
    v_mfma_f32_32x32x16_bf16 v[56:71], v[144:147], v[112:115], v[56:71]
    v_mfma_f32_32x32x16_bf16 v[8:23], v[140:143], v[108:111], v[8:23]
    v_mfma_f32_32x32x16_bf16 v[24:39], v[140:143], v[116:119], v[24:39]
    v_mfma_f32_32x32x16_bf16 v[40:55], v[148:151], v[108:111], v[40:55]
    v_mfma_f32_32x32x16_bf16 v[56:71], v[148:151], v[116:119], v[56:71]
    s_waitcnt vmcnt(8)
    ds_read_b64_tr_b16 v[152:153], v4 offset:4096
    ds_read_b64_tr_b16 v[154:155], v4 offset:4608
    ds_read_b64_tr_b16 v[160:161], v5 offset:4096
    ds_read_b64_tr_b16 v[162:163], v5 offset:4608
    ds_read_b64_tr_b16 v[156:157], v4 offset:6144
    ds_read_b64_tr_b16 v[158:159], v4 offset:6656
    ds_read_b64_tr_b16 v[164:165], v5 offset:6144
    ds_read_b64_tr_b16 v[166:167], v5 offset:6656
    s_and_b32 s51, s34, s35
    s_cbranch_scc1 L_dn_go9
L_dn_poll9:
    global_load_dword v7, v6, s[40:41] sc1
    s_waitcnt vmcnt(0)
    v_cmp_ne_u32 vcc, 0, v7
    s_nop 3
    s_mov_b32 s34, vcc_lo
    s_sub_u32 s52, s52, 1
    s_cmp_eq_u32 s52, 0
    s_cselect_b32 s34, -1, s34
    s_and_b32 s51, s34, s35
    s_cbranch_scc1 L_dn_go9
    s_sleep 6
    s_branch L_dn_poll9
L_dn_go9:
    s_ff1_i32_b32 s51, s51
    s_bitset0_b32 s35, s51
    s_lshl_b32 s22, s51, 10
    s_lshl_b32 s23, s51, 16
    s_add_u32 m0, s28, 0
    s_add_u32 s53, s23, 32768
    buffer_load_dwordx4 v[88:91], v0, s[8:11], s22 offen offset:0 sc1
    buffer_load_dwordx4 v[92:95], v0, s[8:11], s22 offen offset:512 sc1
    buffer_load_dwordx4 v[96:99], v1, s[8:11], s22 offen offset:0 sc1
    buffer_load_dwordx4 v[100:103], v1, s[8:11], s22 offen offset:512 sc1
    buffer_load_dwordx4 v2, s[12:15], s23 offen lds
    s_add_u32 m0, m0, 0x400
    s_nop 0
    buffer_load_dwordx4 v3, s[12:15], s23 offen lds
    s_add_u32 m0, m0, 0x400
    s_nop 0
    buffer_load_dwordx4 v2, s[12:15], s53 offen lds
    s_add_u32 m0, m0, 0x400
    s_nop 0
    buffer_load_dwordx4 v3, s[12:15], s53 offen lds
    s_add_u32 m0, m0, 0x400
    s_nop 0
    s_waitcnt lgkmcnt(0)
    v_mfma_f32_32x32x16_bf16 v[8:23], v[152:155], v[120:123], v[8:23]
    v_mfma_f32_32x32x16_bf16 v[24:39], v[152:155], v[128:131], v[24:39]
    v_mfma_f32_32x32x16_bf16 v[40:55], v[160:163], v[120:123], v[40:55]
    v_mfma_f32_32x32x16_bf16 v[56:71], v[160:163], v[128:131], v[56:71]
    v_mfma_f32_32x32x16_bf16 v[8:23], v[156:159], v[124:127], v[8:23]
    v_mfma_f32_32x32x16_bf16 v[24:39], v[156:159], v[132:135], v[24:39]
    v_mfma_f32_32x32x16_bf16 v[40:55], v[164:167], v[124:127], v[40:55]
    v_mfma_f32_32x32x16_bf16 v[56:71], v[164:167], v[132:135], v[56:71]
    s_waitcnt vmcnt(8)
    ds_read_b64_tr_b16 v[136:137], v4 offset:8192
    ds_read_b64_tr_b16 v[138:139], v4 offset:8704
    ds_read_b64_tr_b16 v[144:145], v5 offset:8192
    ds_read_b64_tr_b16 v[146:147], v5 offset:8704
    ds_read_b64_tr_b16 v[140:141], v4 offset:10240
    ds_read_b64_tr_b16 v[142:143], v4 offset:10752
    ds_read_b64_tr_b16 v[148:149], v5 offset:10240
    ds_read_b64_tr_b16 v[150:151], v5 offset:10752
    s_and_b32 s51, s34, s35
    s_cbranch_scc1 L_dn_go10
L_dn_poll10:
    global_load_dword v7, v6, s[40:41] sc1
    s_waitcnt vmcnt(0)
    v_cmp_ne_u32 vcc, 0, v7
    s_nop 3
    s_mov_b32 s34, vcc_lo
    s_sub_u32 s52, s52, 1
    s_cmp_eq_u32 s52, 0
    s_cselect_b32 s34, -1, s34
    s_and_b32 s51, s34, s35
    s_cbranch_scc1 L_dn_go10
    s_sleep 6
    s_branch L_dn_poll10
L_dn_go10:
    s_ff1_i32_b32 s51, s51
    s_bitset0_b32 s35, s51
    s_lshl_b32 s22, s51, 10
    s_lshl_b32 s23, s51, 16
    s_add_u32 m0, s28, 4096
    s_add_u32 s53, s23, 32768
    buffer_load_dwordx4 v[104:107], v0, s[8:11], s22 offen offset:0 sc1
    buffer_load_dwordx4 v[108:111], v0, s[8:11], s22 offen offset:512 sc1
    buffer_load_dwordx4 v[112:115], v1, s[8:11], s22 offen offset:0 sc1
    buffer_load_dwordx4 v[116:119], v1, s[8:11], s22 offen offset:512 sc1
    buffer_load_dwordx4 v2, s[12:15], s23 offen lds
    s_add_u32 m0, m0, 0x400
    s_nop 0
    buffer_load_dwordx4 v3, s[12:15], s23 offen lds
    s_add_u32 m0, m0, 0x400
    s_nop 0
    buffer_load_dwordx4 v2, s[12:15], s53 offen lds
    s_add_u32 m0, m0, 0x400
    s_nop 0
    buffer_load_dwordx4 v3, s[12:15], s53 offen lds
    s_add_u32 m0, m0, 0x400
    s_nop 0
    s_waitcnt lgkmcnt(0)
    v_mfma_f32_32x32x16_bf16 v[8:23], v[136:139], v[72:75], v[8:23]
    v_mfma_f32_32x32x16_bf16 v[24:39], v[136:139], v[80:83], v[24:39]
    v_mfma_f32_32x32x16_bf16 v[40:55], v[144:147], v[72:75], v[40:55]
    v_mfma_f32_32x32x16_bf16 v[56:71], v[144:147], v[80:83], v[56:71]
    v_mfma_f32_32x32x16_bf16 v[8:23], v[140:143], v[76:79], v[8:23]
    v_mfma_f32_32x32x16_bf16 v[24:39], v[140:143], v[84:87], v[24:39]
    v_mfma_f32_32x32x16_bf16 v[40:55], v[148:151], v[76:79], v[40:55]
    v_mfma_f32_32x32x16_bf16 v[56:71], v[148:151], v[84:87], v[56:71]
    s_waitcnt vmcnt(8)
    ds_read_b64_tr_b16 v[152:153], v4 offset:0
    ds_read_b64_tr_b16 v[154:155], v4 offset:512
    ds_read_b64_tr_b16 v[160:161], v5 offset:0
    ds_read_b64_tr_b16 v[162:163], v5 offset:512
    ds_read_b64_tr_b16 v[156:157], v4 offset:2048
    ds_read_b64_tr_b16 v[158:159], v4 offset:2560
    ds_read_b64_tr_b16 v[164:165], v5 offset:2048
    ds_read_b64_tr_b16 v[166:167], v5 offset:2560
    s_and_b32 s51, s34, s35
    s_cbranch_scc1 L_dn_go11
L_dn_poll11:
    global_load_dword v7, v6, s[40:41] sc1
    s_waitcnt vmcnt(0)
    v_cmp_ne_u32 vcc, 0, v7
    s_nop 3
    s_mov_b32 s34, vcc_lo
    s_sub_u32 s52, s52, 1
    s_cmp_eq_u32 s52, 0
    s_cselect_b32 s34, -1, s34
    s_and_b32 s51, s34, s35
    s_cbranch_scc1 L_dn_go11
    s_sleep 6
    s_branch L_dn_poll11
L_dn_go11:
    s_ff1_i32_b32 s51, s51
    s_bitset0_b32 s35, s51
    s_lshl_b32 s22, s51, 10
    s_lshl_b32 s23, s51, 16
    s_add_u32 m0, s28, 8192
    s_add_u32 s53, s23, 32768
    buffer_load_dwordx4 v[120:123], v0, s[8:11], s22 offen offset:0 sc1
    buffer_load_dwordx4 v[124:127], v0, s[8:11], s22 offen offset:512 sc1
    buffer_load_dwordx4 v[128:131], v1, s[8:11], s22 offen offset:0 sc1
    buffer_load_dwordx4 v[132:135], v1, s[8:11], s22 offen offset:512 sc1
    buffer_load_dwordx4 v2, s[12:15], s23 offen lds
    s_add_u32 m0, m0, 0x400
    s_nop 0
    buffer_load_dwordx4 v3, s[12:15], s23 offen lds
    s_add_u32 m0, m0, 0x400
    s_nop 0
    buffer_load_dwordx4 v2, s[12:15], s53 offen lds
    s_add_u32 m0, m0, 0x400
    s_nop 0
    buffer_load_dwordx4 v3, s[12:15], s53 offen lds
    s_add_u32 m0, m0, 0x400
    s_nop 0
    s_waitcnt lgkmcnt(0)
    v_mfma_f32_32x32x16_bf16 v[8:23], v[152:155], v[88:91], v[8:23]
    v_mfma_f32_32x32x16_bf16 v[24:39], v[152:155], v[96:99], v[24:39]
    v_mfma_f32_32x32x16_bf16 v[40:55], v[160:163], v[88:91], v[40:55]
    v_mfma_f32_32x32x16_bf16 v[56:71], v[160:163], v[96:99], v[56:71]
    v_mfma_f32_32x32x16_bf16 v[8:23], v[156:159], v[92:95], v[8:23]
    v_mfma_f32_32x32x16_bf16 v[24:39], v[156:159], v[100:103], v[24:39]
    v_mfma_f32_32x32x16_bf16 v[40:55], v[164:167], v[92:95], v[40:55]
    v_mfma_f32_32x32x16_bf16 v[56:71], v[164:167], v[100:103], v[56:71]
    s_waitcnt vmcnt(8)
    ds_read_b64_tr_b16 v[136:137], v4 offset:4096
    ds_read_b64_tr_b16 v[138:139], v4 offset:4608
    ds_read_b64_tr_b16 v[144:145], v5 offset:4096
    ds_read_b64_tr_b16 v[146:147], v5 offset:4608
    ds_read_b64_tr_b16 v[140:141], v4 offset:6144
    ds_read_b64_tr_b16 v[142:143], v4 offset:6656
    ds_read_b64_tr_b16 v[148:149], v5 offset:6144
    ds_read_b64_tr_b16 v[150:151], v5 offset:6656
    s_and_b32 s51, s34, s35
    s_cbranch_scc1 L_dn_go12
L_dn_poll12:
    global_load_dword v7, v6, s[40:41] sc1
    s_waitcnt vmcnt(0)
    v_cmp_ne_u32 vcc, 0, v7
    s_nop 3
    s_mov_b32 s34, vcc_lo
    s_sub_u32 s52, s52, 1
    s_cmp_eq_u32 s52, 0
    s_cselect_b32 s34, -1, s34
    s_and_b32 s51, s34, s35
    s_cbranch_scc1 L_dn_go12
    s_sleep 6
    s_branch L_dn_poll12
L_dn_go12:
    s_ff1_i32_b32 s51, s51
    s_bitset0_b32 s35, s51
    s_lshl_b32 s22, s51, 10
    s_lshl_b32 s23, s51, 16
    s_add_u32 m0, s28, 0
    s_add_u32 s53, s23, 32768
    buffer_load_dwordx4 v[72:75], v0, s[8:11], s22 offen offset:0 sc1
    buffer_load_dwordx4 v[76:79], v0, s[8:11], s22 offen offset:512 sc1
    buffer_load_dwordx4 v[80:83], v1, s[8:11], s22 offen offset:0 sc1
    buffer_load_dwordx4 v[84:87], v1, s[8:11], s22 offen offset:512 sc1
    buffer_load_dwordx4 v2, s[12:15], s23 offen lds
    s_add_u32 m0, m0, 0x400
    s_nop 0
    buffer_load_dwordx4 v3, s[12:15], s23 offen lds
    s_add_u32 m0, m0, 0x400
    s_nop 0
    buffer_load_dwordx4 v2, s[12:15], s53 offen lds
    s_add_u32 m0, m0, 0x400
    s_nop 0
    buffer_load_dwordx4 v3, s[12:15], s53 offen lds
    s_add_u32 m0, m0, 0x400
    s_nop 0
    s_waitcnt lgkmcnt(0)
    v_mfma_f32_32x32x16_bf16 v[8:23], v[136:139], v[104:107], v[8:23]
    v_mfma_f32_32x32x16_bf16 v[24:39], v[136:139], v[112:115], v[24:39]
    v_mfma_f32_32x32x16_bf16 v[40:55], v[144:147], v[104:107], v[40:55]
    v_mfma_f32_32x32x16_bf16 v[56:71], v[144:147], v[112:115], v[56:71]
    v_mfma_f32_32x32x16_bf16 v[8:23], v[140:143], v[108:111], v[8:23]
    v_mfma_f32_32x32x16_bf16 v[24:39], v[140:143], v[116:119], v[24:39]
    v_mfma_f32_32x32x16_bf16 v[40:55], v[148:151], v[108:111], v[40:55]
    v_mfma_f32_32x32x16_bf16 v[56:71], v[148:151], v[116:119], v[56:71]
    s_waitcnt vmcnt(8)
    ds_read_b64_tr_b16 v[152:153], v4 offset:8192
    ds_read_b64_tr_b16 v[154:155], v4 offset:8704
    ds_read_b64_tr_b16 v[160:161], v5 offset:8192
    ds_read_b64_tr_b16 v[162:163], v5 offset:8704
    ds_read_b64_tr_b16 v[156:157], v4 offset:10240
    ds_read_b64_tr_b16 v[158:159], v4 offset:10752
    ds_read_b64_tr_b16 v[164:165], v5 offset:10240
    ds_read_b64_tr_b16 v[166:167], v5 offset:10752
    s_and_b32 s51, s34, s35
    s_cbranch_scc1 L_dn_go13
L_dn_poll13:
    global_load_dword v7, v6, s[40:41] sc1
    s_waitcnt vmcnt(0)
    v_cmp_ne_u32 vcc, 0, v7
    s_nop 3
    s_mov_b32 s34, vcc_lo
    s_sub_u32 s52, s52, 1
    s_cmp_eq_u32 s52, 0
    s_cselect_b32 s34, -1, s34
    s_and_b32 s51, s34, s35
    s_cbranch_scc1 L_dn_go13
    s_sleep 6
    s_branch L_dn_poll13
L_dn_go13:
    s_ff1_i32_b32 s51, s51
    s_bitset0_b32 s35, s51
    s_lshl_b32 s22, s51, 10
    s_lshl_b32 s23, s51, 16
    s_add_u32 m0, s28, 4096
    s_add_u32 s53, s23, 32768
    buffer_load_dwordx4 v[88:91], v0, s[8:11], s22 offen offset:0 sc1
    buffer_load_dwordx4 v[92:95], v0, s[8:11], s22 offen offset:512 sc1
    buffer_load_dwordx4 v[96:99], v1, s[8:11], s22 offen offset:0 sc1
    buffer_load_dwordx4 v[100:103], v1, s[8:11], s22 offen offset:512 sc1
    buffer_load_dwordx4 v2, s[12:15], s23 offen lds
    s_add_u32 m0, m0, 0x400
    s_nop 0
    buffer_load_dwordx4 v3, s[12:15], s23 offen lds
    s_add_u32 m0, m0, 0x400
    s_nop 0
    buffer_load_dwordx4 v2, s[12:15], s53 offen lds
    s_add_u32 m0, m0, 0x400
    s_nop 0
    buffer_load_dwordx4 v3, s[12:15], s53 offen lds
    s_add_u32 m0, m0, 0x400
    s_nop 0
    s_waitcnt lgkmcnt(0)
    v_mfma_f32_32x32x16_bf16 v[8:23], v[152:155], v[120:123], v[8:23]
    v_mfma_f32_32x32x16_bf16 v[24:39], v[152:155], v[128:131], v[24:39]
    v_mfma_f32_32x32x16_bf16 v[40:55], v[160:163], v[120:123], v[40:55]
    v_mfma_f32_32x32x16_bf16 v[56:71], v[160:163], v[128:131], v[56:71]
    v_mfma_f32_32x32x16_bf16 v[8:23], v[156:159], v[124:127], v[8:23]
    v_mfma_f32_32x32x16_bf16 v[24:39], v[156:159], v[132:135], v[24:39]
    v_mfma_f32_32x32x16_bf16 v[40:55], v[164:167], v[124:127], v[40:55]
    v_mfma_f32_32x32x16_bf16 v[56:71], v[164:167], v[132:135], v[56:71]
    s_waitcnt vmcnt(8)
    ds_read_b64_tr_b16 v[136:137], v4 offset:0
    ds_read_b64_tr_b16 v[138:139], v4 offset:512
    ds_read_b64_tr_b16 v[144:145], v5 offset:0
    ds_read_b64_tr_b16 v[146:147], v5 offset:512
    ds_read_b64_tr_b16 v[140:141], v4 offset:2048
    ds_read_b64_tr_b16 v[142:143], v4 offset:2560
    ds_read_b64_tr_b16 v[148:149], v5 offset:2048
    ds_read_b64_tr_b16 v[150:151], v5 offset:2560
    s_and_b32 s51, s34, s35
    s_cbranch_scc1 L_dn_go14
L_dn_poll14:
    global_load_dword v7, v6, s[40:41] sc1
    s_waitcnt vmcnt(0)
    v_cmp_ne_u32 vcc, 0, v7
    s_nop 3
    s_mov_b32 s34, vcc_lo
    s_sub_u32 s52, s52, 1
    s_cmp_eq_u32 s52, 0
    s_cselect_b32 s34, -1, s34
    s_and_b32 s51, s34, s35
    s_cbranch_scc1 L_dn_go14
    s_sleep 6
    s_branch L_dn_poll14
L_dn_go14:
    s_ff1_i32_b32 s51, s51
    s_bitset0_b32 s35, s51
    s_lshl_b32 s22, s51, 10
    s_lshl_b32 s23, s51, 16
    s_add_u32 m0, s28, 8192
    s_add_u32 s53, s23, 32768
    buffer_load_dwordx4 v[104:107], v0, s[8:11], s22 offen offset:0 sc1
    buffer_load_dwordx4 v[108:111], v0, s[8:11], s22 offen offset:512 sc1
    buffer_load_dwordx4 v[112:115], v1, s[8:11], s22 offen offset:0 sc1
    buffer_load_dwordx4 v[116:119], v1, s[8:11], s22 offen offset:512 sc1
    buffer_load_dwordx4 v2, s[12:15], s23 offen lds
    s_add_u32 m0, m0, 0x400
    s_nop 0
    buffer_load_dwordx4 v3, s[12:15], s23 offen lds
    s_add_u32 m0, m0, 0x400
    s_nop 0
    buffer_load_dwordx4 v2, s[12:15], s53 offen lds
    s_add_u32 m0, m0, 0x400
    s_nop 0
    buffer_load_dwordx4 v3, s[12:15], s53 offen lds
    s_add_u32 m0, m0, 0x400
    s_nop 0
    s_waitcnt lgkmcnt(0)
    v_mfma_f32_32x32x16_bf16 v[8:23], v[136:139], v[72:75], v[8:23]
    v_mfma_f32_32x32x16_bf16 v[24:39], v[136:139], v[80:83], v[24:39]
    v_mfma_f32_32x32x16_bf16 v[40:55], v[144:147], v[72:75], v[40:55]
    v_mfma_f32_32x32x16_bf16 v[56:71], v[144:147], v[80:83], v[56:71]
    v_mfma_f32_32x32x16_bf16 v[8:23], v[140:143], v[76:79], v[8:23]
    v_mfma_f32_32x32x16_bf16 v[24:39], v[140:143], v[84:87], v[24:39]
    v_mfma_f32_32x32x16_bf16 v[40:55], v[148:151], v[76:79], v[40:55]
    v_mfma_f32_32x32x16_bf16 v[56:71], v[148:151], v[84:87], v[56:71]
    s_waitcnt vmcnt(8)
    ds_read_b64_tr_b16 v[152:153], v4 offset:4096
    ds_read_b64_tr_b16 v[154:155], v4 offset:4608
    ds_read_b64_tr_b16 v[160:161], v5 offset:4096
    ds_read_b64_tr_b16 v[162:163], v5 offset:4608
    ds_read_b64_tr_b16 v[156:157], v4 offset:6144
    ds_read_b64_tr_b16 v[158:159], v4 offset:6656
    ds_read_b64_tr_b16 v[164:165], v5 offset:6144
    ds_read_b64_tr_b16 v[166:167], v5 offset:6656
    s_and_b32 s51, s34, s35
    s_cbranch_scc1 L_dn_go15
L_dn_poll15:
    global_load_dword v7, v6, s[40:41] sc1
    s_waitcnt vmcnt(0)
    v_cmp_ne_u32 vcc, 0, v7
    s_nop 3
    s_mov_b32 s34, vcc_lo
    s_sub_u32 s52, s52, 1
    s_cmp_eq_u32 s52, 0
    s_cselect_b32 s34, -1, s34
    s_and_b32 s51, s34, s35
    s_cbranch_scc1 L_dn_go15
    s_sleep 6
    s_branch L_dn_poll15
L_dn_go15:
    s_ff1_i32_b32 s51, s51
    s_bitset0_b32 s35, s51
    s_lshl_b32 s22, s51, 10
    s_lshl_b32 s23, s51, 16
    s_add_u32 m0, s28, 0
    s_add_u32 s53, s23, 32768
    buffer_load_dwordx4 v[120:123], v0, s[8:11], s22 offen offset:0 sc1
    buffer_load_dwordx4 v[124:127], v0, s[8:11], s22 offen offset:512 sc1
    buffer_load_dwordx4 v[128:131], v1, s[8:11], s22 offen offset:0 sc1
    buffer_load_dwordx4 v[132:135], v1, s[8:11], s22 offen offset:512 sc1
    buffer_load_dwordx4 v2, s[12:15], s23 offen lds
    s_add_u32 m0, m0, 0x400
    s_nop 0
    buffer_load_dwordx4 v3, s[12:15], s23 offen lds
    s_add_u32 m0, m0, 0x400
    s_nop 0
    buffer_load_dwordx4 v2, s[12:15], s53 offen lds
    s_add_u32 m0, m0, 0x400
    s_nop 0
    buffer_load_dwordx4 v3, s[12:15], s53 offen lds
    s_add_u32 m0, m0, 0x400
    s_nop 0
    s_waitcnt lgkmcnt(0)
    v_mfma_f32_32x32x16_bf16 v[8:23], v[152:155], v[88:91], v[8:23]
    v_mfma_f32_32x32x16_bf16 v[24:39], v[152:155], v[96:99], v[24:39]
    v_mfma_f32_32x32x16_bf16 v[40:55], v[160:163], v[88:91], v[40:55]
    v_mfma_f32_32x32x16_bf16 v[56:71], v[160:163], v[96:99], v[56:71]
    v_mfma_f32_32x32x16_bf16 v[8:23], v[156:159], v[92:95], v[8:23]
    v_mfma_f32_32x32x16_bf16 v[24:39], v[156:159], v[100:103], v[24:39]
    v_mfma_f32_32x32x16_bf16 v[40:55], v[164:167], v[92:95], v[40:55]
    v_mfma_f32_32x32x16_bf16 v[56:71], v[164:167], v[100:103], v[56:71]
    s_waitcnt vmcnt(8)
    ds_read_b64_tr_b16 v[136:137], v4 offset:8192
    ds_read_b64_tr_b16 v[138:139], v4 offset:8704
    ds_read_b64_tr_b16 v[144:145], v5 offset:8192
    ds_read_b64_tr_b16 v[146:147], v5 offset:8704
    ds_read_b64_tr_b16 v[140:141], v4 offset:10240
    ds_read_b64_tr_b16 v[142:143], v4 offset:10752
    ds_read_b64_tr_b16 v[148:149], v5 offset:10240
    ds_read_b64_tr_b16 v[150:151], v5 offset:10752
    s_waitcnt lgkmcnt(0)
    v_mfma_f32_32x32x16_bf16 v[8:23], v[136:139], v[104:107], v[8:23]
    v_mfma_f32_32x32x16_bf16 v[24:39], v[136:139], v[112:115], v[24:39]
    v_mfma_f32_32x32x16_bf16 v[40:55], v[144:147], v[104:107], v[40:55]
    v_mfma_f32_32x32x16_bf16 v[56:71], v[144:147], v[112:115], v[56:71]
    v_mfma_f32_32x32x16_bf16 v[8:23], v[140:143], v[108:111], v[8:23]
    v_mfma_f32_32x32x16_bf16 v[24:39], v[140:143], v[116:119], v[24:39]
    v_mfma_f32_32x32x16_bf16 v[40:55], v[148:151], v[108:111], v[40:55]
    v_mfma_f32_32x32x16_bf16 v[56:71], v[148:151], v[116:119], v[56:71]
    s_waitcnt vmcnt(0)
    ds_read_b64_tr_b16 v[152:153], v4 offset:0
    ds_read_b64_tr_b16 v[154:155], v4 offset:512
    ds_read_b64_tr_b16 v[160:161], v5 offset:0
    ds_read_b64_tr_b16 v[162:163], v5 offset:512
    ds_read_b64_tr_b16 v[156:157], v4 offset:2048
    ds_read_b64_tr_b16 v[158:159], v4 offset:2560
    ds_read_b64_tr_b16 v[164:165], v5 offset:2048
    ds_read_b64_tr_b16 v[166:167], v5 offset:2560
    s_waitcnt lgkmcnt(0)
    v_mfma_f32_32x32x16_bf16 v[8:23], v[152:155], v[120:123], v[8:23]
    v_mfma_f32_32x32x16_bf16 v[24:39], v[152:155], v[128:131], v[24:39]
    v_mfma_f32_32x32x16_bf16 v[40:55], v[160:163], v[120:123], v[40:55]
    v_mfma_f32_32x32x16_bf16 v[56:71], v[160:163], v[128:131], v[56:71]
    v_mfma_f32_32x32x16_bf16 v[8:23], v[156:159], v[124:127], v[8:23]
    v_mfma_f32_32x32x16_bf16 v[24:39], v[156:159], v[132:135], v[24:39]
    v_mfma_f32_32x32x16_bf16 v[40:55], v[164:167], v[124:127], v[40:55]
    v_mfma_f32_32x32x16_bf16 v[56:71], v[164:167], v[132:135], v[56:71]
    v_mbcnt_lo_u32_b32 v2, -1, 0
    v_mbcnt_hi_u32_b32 v2, -1, v2
    v_and_b32 v3, 31, v2
    v_lshrrev_b32 v4, 5, v2
    s_lshl_b32 s51, s42, 7
    s_lshl_b32 s52, s48, 6
    s_add_u32 s51, s51, s52
    v_add_u32 v6, s51, v3
    v_lshlrev_b32 v6, 11, v6
    s_lshl_b32 s51, s43, 7
    s_lshl_b32 s52, s49, 6
    s_add_u32 s51, s51, s52
    v_add_u32 v6, s51, v6
    v_lshl_add_u32 v7, v4, 4, v6
    v_lshl_add_u32 v6, v4, 3, v6
    s_mov_b32 s51, 65536
    s_nop 7
    s_barrier
    s_lshl_b32 s52, s20, 13
    s_xor_b32 s53, s52, 16384
    v_lshlrev_b32 v5, 4, v2
    v_add_u32 v0, s53, v5
    v_add_u32 v5, s52, v5
    s_cmp_eq_u32 s49, 0
    s_cbranch_scc1 L_dn_k0
    ds_write_b128 v0, v[8:11] offset:0
    ds_write_b128 v0, v[12:15] offset:1024
    ds_write_b128 v0, v[16:19] offset:2048
    ds_write_b128 v0, v[20:23] offset:3072
    ds_write_b128 v0, v[24:27] offset:4096
    ds_write_b128 v0, v[28:31] offset:5120
    ds_write_b128 v0, v[32:35] offset:6144
    ds_write_b128 v0, v[36:39] offset:7168
    s_waitcnt lgkmcnt(0)
    s_barrier
    ds_read_b128 v[104:107], v5 offset:0
    ds_read_b128 v[108:111], v5 offset:1024
    ds_read_b128 v[112:115], v5 offset:2048
    ds_read_b128 v[116:119], v5 offset:3072
    ds_read_b128 v[120:123], v5 offset:4096
    ds_read_b128 v[124:127], v5 offset:5120
    ds_read_b128 v[128:131], v5 offset:6144
    ds_read_b128 v[132:135], v5 offset:7168
    s_waitcnt vmcnt(0) lgkmcnt(0)
    v_add_f32 v40, v40, v104
    v_add_f32 v41, v41, v105
    v_add_f32 v42, v42, v106
    v_add_f32 v43, v43, v107
    v_cvt_pk_bf16_f32 v136, v40, v41
    v_cvt_pk_bf16_f32 v137, v42, v43
    v_add_f32 v44, v44, v108
    v_add_f32 v45, v45, v109
    v_add_f32 v46, v46, v110
    v_add_f32 v47, v47, v111
    v_cvt_pk_bf16_f32 v138, v44, v45
    v_cvt_pk_bf16_f32 v139, v46, v47
    v_add_f32 v48, v48, v112
    v_add_f32 v49, v49, v113
    v_add_f32 v50, v50, v114
    v_add_f32 v51, v51, v115
    v_cvt_pk_bf16_f32 v140, v48, v49
    v_cvt_pk_bf16_f32 v141, v50, v51
    v_add_f32 v52, v52, v116
    v_add_f32 v53, v53, v117
    v_add_f32 v54, v54, v118
    v_add_f32 v55, v55, v119
    v_cvt_pk_bf16_f32 v142, v52, v53
    v_cvt_pk_bf16_f32 v143, v54, v55
    v_add_f32 v56, v56, v120
    v_add_f32 v57, v57, v121
    v_add_f32 v58, v58, v122
    v_add_f32 v59, v59, v123
    v_cvt_pk_bf16_f32 v144, v56, v57
    v_cvt_pk_bf16_f32 v145, v58, v59
    v_add_f32 v60, v60, v124
    v_add_f32 v61, v61, v125
    v_add_f32 v62, v62, v126
    v_add_f32 v63, v63, v127
    v_cvt_pk_bf16_f32 v146, v60, v61
    v_cvt_pk_bf16_f32 v147, v62, v63
    v_add_f32 v64, v64, v128
    v_add_f32 v65, v65, v129
    v_add_f32 v66, v66, v130
    v_add_f32 v67, v67, v131
    v_cvt_pk_bf16_f32 v148, v64, v65
    v_cvt_pk_bf16_f32 v149, v66, v67
    v_add_f32 v68, v68, v132
    v_add_f32 v69, v69, v133
    v_add_f32 v70, v70, v134
    v_add_f32 v71, v71, v135
    v_cvt_pk_bf16_f32 v150, v68, v69
    v_cvt_pk_bf16_f32 v151, v70, v71
    s_nop 1
    v_permlane32_swap_b32 v136, v138
    v_permlane32_swap_b32 v137, v139
    v_permlane32_swap_b32 v140, v142
    v_permlane32_swap_b32 v141, v143
    v_permlane32_swap_b32 v144, v146
    v_permlane32_swap_b32 v145, v147
    v_permlane32_swap_b32 v148, v150
    v_permlane32_swap_b32 v149, v151
    buffer_store_dwordx4 v[136:139], v7, s[24:27], 0 offen offset:0
    buffer_store_dwordx4 v[140:143], v7, s[24:27], 0 offen offset:32
    buffer_store_dwordx4 v[144:147], v7, s[24:27], s51 offen offset:0
    buffer_store_dwordx4 v[148:151], v7, s[24:27], s51 offen offset:32
    s_endpgm
L_dn_k0:
    ds_write_b128 v0, v[40:43] offset:0
    ds_write_b128 v0, v[44:47] offset:1024
    ds_write_b128 v0, v[48:51] offset:2048
    ds_write_b128 v0, v[52:55] offset:3072
    ds_write_b128 v0, v[56:59] offset:4096
    ds_write_b128 v0, v[60:63] offset:5120
    ds_write_b128 v0, v[64:67] offset:6144
    ds_write_b128 v0, v[68:71] offset:7168
    s_waitcnt lgkmcnt(0)
    s_barrier
    ds_read_b128 v[104:107], v5 offset:0
    ds_read_b128 v[108:111], v5 offset:1024
    ds_read_b128 v[112:115], v5 offset:2048
    ds_read_b128 v[116:119], v5 offset:3072
    ds_read_b128 v[120:123], v5 offset:4096
    ds_read_b128 v[124:127], v5 offset:5120
    ds_read_b128 v[128:131], v5 offset:6144
    ds_read_b128 v[132:135], v5 offset:7168
    s_waitcnt vmcnt(0) lgkmcnt(0)
    v_add_f32 v8, v8, v104
    v_add_f32 v9, v9, v105
    v_add_f32 v10, v10, v106
    v_add_f32 v11, v11, v107
    v_cvt_pk_bf16_f32 v136, v8, v9
    v_cvt_pk_bf16_f32 v137, v10, v11
    v_add_f32 v12, v12, v108
    v_add_f32 v13, v13, v109
    v_add_f32 v14, v14, v110
    v_add_f32 v15, v15, v111
    v_cvt_pk_bf16_f32 v138, v12, v13
    v_cvt_pk_bf16_f32 v139, v14, v15
    v_add_f32 v16, v16, v112
    v_add_f32 v17, v17, v113
    v_add_f32 v18, v18, v114
    v_add_f32 v19, v19, v115
    v_cvt_pk_bf16_f32 v140, v16, v17
    v_cvt_pk_bf16_f32 v141, v18, v19
    v_add_f32 v20, v20, v116
    v_add_f32 v21, v21, v117
    v_add_f32 v22, v22, v118
    v_add_f32 v23, v23, v119
    v_cvt_pk_bf16_f32 v142, v20, v21
    v_cvt_pk_bf16_f32 v143, v22, v23
    v_add_f32 v24, v24, v120
    v_add_f32 v25, v25, v121
    v_add_f32 v26, v26, v122
    v_add_f32 v27, v27, v123
    v_cvt_pk_bf16_f32 v144, v24, v25
    v_cvt_pk_bf16_f32 v145, v26, v27
    v_add_f32 v28, v28, v124
    v_add_f32 v29, v29, v125
    v_add_f32 v30, v30, v126
    v_add_f32 v31, v31, v127
    v_cvt_pk_bf16_f32 v146, v28, v29
    v_cvt_pk_bf16_f32 v147, v30, v31
    v_add_f32 v32, v32, v128
    v_add_f32 v33, v33, v129
    v_add_f32 v34, v34, v130
    v_add_f32 v35, v35, v131
    v_cvt_pk_bf16_f32 v148, v32, v33
    v_cvt_pk_bf16_f32 v149, v34, v35
    v_add_f32 v36, v36, v132
    v_add_f32 v37, v37, v133
    v_add_f32 v38, v38, v134
    v_add_f32 v39, v39, v135
    v_cvt_pk_bf16_f32 v150, v36, v37
    v_cvt_pk_bf16_f32 v151, v38, v39
    s_nop 1
    v_permlane32_swap_b32 v136, v138
    v_permlane32_swap_b32 v137, v139
    v_permlane32_swap_b32 v140, v142
    v_permlane32_swap_b32 v141, v143
    v_permlane32_swap_b32 v144, v146
    v_permlane32_swap_b32 v145, v147
    v_permlane32_swap_b32 v148, v150
    v_permlane32_swap_b32 v149, v151
    buffer_store_dwordx4 v[136:139], v7, s[24:27], 0 offen offset:0
    buffer_store_dwordx4 v[140:143], v7, s[24:27], 0 offen offset:32
    buffer_store_dwordx4 v[144:147], v7, s[24:27], s51 offen offset:0
    buffer_store_dwordx4 v[148:151], v7, s[24:27], s51 offen offset:32
    s_endpgm
L_mid_done:
    s_endpgm
.section .rodata,"a"
.p2align 6
.amdhsa_kernel ln_kernel
  .amdhsa_next_free_vgpr 40
  .amdhsa_next_free_sgpr 102
  .amdhsa_accum_offset 40
  .amdhsa_group_segment_fixed_size 0
  .amdhsa_kernarg_size 80
  .amdhsa_user_sgpr_count 2
  .amdhsa_user_sgpr_kernarg_segment_ptr 1
  .amdhsa_system_sgpr_workgroup_id_x 1
.end_amdhsa_kernel
.p2align 6
.amdhsa_kernel gemm1_kernel
  .amdhsa_next_free_vgpr 256
  .amdhsa_next_free_sgpr 102
  .amdhsa_accum_offset 256
  .amdhsa_group_segment_fixed_size 0
  .amdhsa_kernarg_size 80
  .amdhsa_user_sgpr_count 2
  .amdhsa_user_sgpr_kernarg_segment_ptr 1
  .amdhsa_system_sgpr_workgroup_id_x 1
.end_amdhsa_kernel
.p2align 6
.amdhsa_kernel mid_kernel
  .amdhsa_next_free_vgpr 168
  .amdhsa_next_free_sgpr 102
  .amdhsa_accum_offset 168
  .amdhsa_group_segment_fixed_size 0
  .amdhsa_kernarg_size 80
  .amdhsa_user_sgpr_count 2
  .amdhsa_user_sgpr_kernarg_segment_ptr 1
  .amdhsa_system_sgpr_workgroup_id_x 1
.end_amdhsa_kernel
```
